```python
import torch

def _softmax(x, axis=-1):
    return torch.softmax(x, dim=axis)

def _gelu(x):
    return torch.nn.functional.gelu(x, approximate='tanh')

def _silu(x):
    return torch.nn.functional.silu(x)

def _sigmoid(x):
    return torch.sigmoid(x)

def _layernorm(x, axis=-1, eps=1e-05):
    m = x.mean(dim=axis, keepdim=True)
    v = x.var(dim=axis, keepdim=True, unbiased=False)
    return (x - m) / torch.sqrt(v + eps)

def _scatter_add(tgt, idx, src, axis=0):
    return tgt.clone().index_add_(axis, idx, src)

def _segment_sum(src, seg, n):
    out = torch.zeros((n,) + src.shape[1:], dtype=src.dtype)
    return out.index_add_(0, seg, src)

def _pad(x, pw):
    flat = tuple((v for pair in reversed(pw) for v in pair))
    return torch.nn.functional.pad(x, flat)
kernel_name = 'adaLN_cond__mha_block_cached__geglu_ffn__decode'

def setup_inputs():

    _w = lambda a: (lambda t: t.to(torch.bfloat16) if t.is_floating_point() else t)(torch.as_tensor(a))

    def _A_setup():
        B, Sq, D = (2, 1, 576)
        H, Sk, Dh = (32, 4096, 128)
        return {'x': _w((lambda *s: torch.randn(*s, dtype=torch.bfloat16) * 0.1)(B, Sq, D)), 'k_cache': _w((lambda *s: torch.randn(*s, dtype=torch.bfloat16) * 0.8)(B, H, Sk, Dh)), 'v_cache': _w((lambda *s: torch.randn(*s, dtype=torch.bfloat16) * 0.8)(B, H, Sk, Dh)), 'wq': _w((lambda *s: torch.randn(*s, dtype=torch.bfloat16) * 0.8)(D, H * Dh) * D ** (-0.5)), 'wo': _w((lambda *s: torch.randn(*s, dtype=torch.bfloat16) * 0.8)(H * Dh, D) * (H * Dh) ** (-0.5))}
    _A_in = _A_setup()

    def _B_setup():
        B, S, D, F = (2, 1, 576, 4608)
        return {'x': _w((lambda *s: torch.randn(*s, dtype=torch.bfloat16) * 0.1)(B, S, D)), 'w_gate': _w((lambda *s: torch.randn(*s, dtype=torch.bfloat16) * 0.1)(D, F)), 'w_up': _w((lambda *s: torch.randn(*s, dtype=torch.bfloat16) * 0.1)(D, F)), 'w_down': _w((lambda *s: torch.randn(*s, dtype=torch.bfloat16) * 0.1)(F, D))}
    _B_in = _B_setup()
    return {'A_x': _A_in['x'], 'A_k_cache': _A_in['k_cache'], 'A_v_cache': _A_in['v_cache'], 'A_wq': _A_in['wq'], 'A_wo': _A_in['wo'], 'B_x': _B_in['x'], 'B_w_gate': _B_in['w_gate'], 'B_w_up': _B_in['w_up'], 'B_w_down': _B_in['w_down'], 'c': _w((lambda *s: torch.randn(*s, dtype=torch.bfloat16) * 0.4)(2, 576) * 8.0), 'w_mod': _w((lambda *s: torch.randn(*s, dtype=torch.bfloat16) * 0.4)(576, 6 * 576) * 576 ** (-0.5) * 8.0)}

def reference(A_x, A_k_cache, A_v_cache, A_wq, A_wo, B_x, B_w_gate, B_w_up, B_w_down, c, w_mod):

    def _A_ref(x, k_cache, v_cache, wq, wo):
        B, Sq, D = x.shape
        H, Dh = (32, 128)
        q = (lambda x, *d: x.permute(*d))((x @ wq).reshape(B, Sq, H, Dh), 0, 2, 1, 3)
        scores = torch.einsum('bhqd,bhkd->bhqk', q, k_cache) * Dh ** (-0.5)
        p = _softmax(scores, axis=-1)
        o = torch.einsum('bhqk,bhkd->bhqd', p, v_cache)
        return (lambda x, *d: x.permute(*d))(o, 0, 2, 1, 3).reshape(B, Sq, H * Dh) @ wo

    def _B_ref(x, w_gate, w_up, w_down):
        return _gelu(x @ w_gate) * (x @ w_up) @ w_down
    x = A_x
    mod = (_silu(c) @ w_mod).reshape(c.shape[0], 6, 1, -1)
    sa, ca, ga, sb, cb, gb = (mod[:, 0].clone(), mod[:, 1].clone(), mod[:, 2].clone(), mod[:, 3].clone(), mod[:, 4].clone(), mod[:, 5].clone())
    h = _layernorm(x, axis=-1) * (1 + ca) + sa
    x = x + ga * _A_ref(h, A_k_cache, A_v_cache, A_wq, A_wo)
    h = _layernorm(x, axis=-1) * (1 + cb) + sb
    x = x + gb * _B_ref(h, B_w_gate, B_w_up, B_w_down)
    return x
```

```asm
; @launch grid=(256,1,1) block=(1024,1,1) lds=157696
.amdgcn_target "amdgcn-amd-amdhsa--gfx950"
.text
.globl adaLN_cond__mha_block_cached__geglu_ffn__decode_kernel
.p2align 8
.type adaLN_cond__mha_block_cached__geglu_ffn__decode_kernel,@function
adaLN_cond__mha_block_cached__geglu_ffn__decode_kernel:
    s_cmp_ge_u32 s2, 256
    s_cbranch_scc1 L_end
    s_load_dwordx16 s[32:47], s[0:1], 0
    s_load_dwordx8 s[48:55], s[0:1], 64
    s_load_dwordx4 s[56:59], s[0:1], 96
    v_and_b32 v1, 63, v0
    v_lshrrev_b32 v2, 6, v0
    v_mov_b32 v0, 0
    v_readfirstlane_b32 s60, v2
    v_mov_b32 v4, 0
    v_mov_b32 v5, 0
    v_mov_b32 v6, 0
    v_mov_b32 v7, 0
    ds_write_b128 v0, v[4:7]
    ds_write_b128 v0, v[4:7] offset:16
    ds_write_b128 v0, v[4:7] offset:32
    s_and_b32 s61, s2, 7
    s_lshr_b32 s62, s2, 3
    s_lshr_b32 s63, s62, 3
    s_lshl_b32 s3, s61, 2
    s_add_u32 s63, s63, s3
    s_and_b32 s64, s62, 7
    s_lshr_b32 s65, s64, 2
    s_and_b32 s66, s64, 3
    s_mul_i32 s68, s61, 18
    s_add_u32 s68, s68, s62
    s_mov_b32 s67, 3
    s_cmp_lt_u32 s62, 18
    s_cbranch_scc1 L_role
    s_lshl_b32 s68, s61, 3
    s_add_u32 s68, s68, s62
    s_sub_u32 s68, s68, 18
    s_mov_b32 s67, 1
    s_cmp_lt_u32 s62, 26
    s_cbranch_scc1 L_role
    s_sub_u32 s68, s2, 208
    s_cmp_lt_u32 s68, 36
    s_cselect_b32 s67, 2, 0
L_role:
    s_lshr_b32 s3, s61, 1
    s_mul_i32 s95, s3, 24
    s_add_u32 s95, s95, s62
    s_cmp_lt_u32 s62, 18
    s_cselect_b32 s70, 0, 8
    s_sub_u32 s95, s95, s70
    s_lshl_b32 s3, s3, 2
    s_add_u32 s3, s3, s62
    s_add_u32 s3, s3, 68
    s_cmp_lt_u32 s62, 28
    s_cselect_b32 s3, 999, s3
    s_bitcmp1_b32 s2, 0
    s_cselect_b32 s95, s3, s95
    s_cmp_eq_u32 s67, 1
    s_cselect_b32 s95, 999, s95
    s_lshr_b32 s98, s95, 1
    s_lshl_b32 s98, s98, 7
    s_lshl_b32 s99, s63, 2
    s_add_u32 s99, s99, s66
    s_lshl_b32 s99, s99, 6
    s_mov_b32 s71, 4096
    s_mov_b32 s72, 8192
    s_mov_b32 s73, 12288
    s_mov_b32 s90, 0xcccccccc
    s_mov_b32 s91, 0xcccccccc
    s_mov_b32 s92, 0xaaaaaaaa
    s_mov_b32 s93, 0xaaaaaaaa
    s_lshl_b32 s3, s60, 14
    v_lshl_add_u32 v2, v1, 4, s3
    s_lshl_b32 s3, s65, 5
    s_add_u32 s94, s3, s63
    s_lshl_b32 s3, s94, 2
    s_add_u32 s3, s3, s66
    s_lshl_b32 s3, s3, 18
    s_waitcnt lgkmcnt(0)
    s_load_dword s88, s[58:59], 114688
    s_add_u32 s4, s34, s3
    s_addc_u32 s5, s35, 0
    s_mov_b32 s6, 262144
    s_mov_b32 s7, 0x20000
    s_add_u32 s8, s36, s3
    s_addc_u32 s9, s37, 0
    s_mov_b32 s10, 262144
    s_mov_b32 s11, 0x20000
    s_mov_b32 s12, s58
    s_mov_b32 s13, s59
    s_mov_b32 s14, 1351680
    s_mov_b32 s15, 0x20000
    s_cmp_eq_u32 s60, 1
    s_cbranch_scc1 L_waveB
    s_mov_b64 vcc, 0
    s_cmp_eq_u32 s60, 0
    s_cbranch_scc0 L_stream
    s_setprio 3
    s_cmp_lt_u32 s95, 108
    s_cbranch_scc1 L_Amod
    s_barrier
    s_branch L_Adone
L_Amod:
    s_mov_b32 s20, s50
    s_mov_b32 s21, s51
    s_mov_b32 s22, 2304
    s_mov_b32 s23, 0x20000
    v_lshrrev_b32 v31, 5, v1
    v_mul_u32_u24 v31, 1152, v31
    v_and_b32 v30, 31, v1
    v_mul_u32_u24 v30, 36, v30
    v_add_u32 v30, v30, v31
    buffer_load_dwordx4 v[20:23], v30, s[20:23], 0 offen offset:0
    buffer_load_dwordx4 v[24:27], v30, s[20:23], 0 offen offset:16
    buffer_load_dword v28, v30, s[20:23], 0 offen offset:32
    s_barrier
    s_lshr_b32 s3, s95, 1
    s_mul_i32 s3, s3, 7282
    s_lshr_b32 s3, s3, 16
    s_mul_i32 s3, s3, 2304
    s_lshl_b32 s98, s98, 1
    s_add_u32 s98, s98, s3
    s_and_b32 s70, s95, 1
    s_mul_i32 s3, s70, 27648
    s_add_u32 s98, s98, s3
    s_mul_i32 s74, s70, 576
    s_add_u32 s74, s74, 512
    v_bfe_u32 v96, v1, 4, 1
    v_mul_u32_u24 v96, 2304, v96
    v_and_b32 v4, 15, v1
    v_lshl_add_u32 v96, v4, 2, v96
    v_lshrrev_b32 v4, 5, v1
    v_lshl_add_u32 v96, v4, 6, v96
    v_add_u32 v96, s98, v96
    s_waitcnt vmcnt(0)
    v_and_b32 v9, 0xffff0000, v20
    v_lshlrev_b32 v8, 16, v20
    v_mul_f32 v10, 0xbfb8aa3b, v8
    v_mul_f32 v11, 0xbfb8aa3b, v9
    v_exp_f32 v10, v10
    v_exp_f32 v11, v11
    v_add_f32 v12, 1.0, v10
    v_add_f32 v13, 1.0, v11
    v_rcp_f32 v10, v12
    v_rcp_f32 v11, v13
    v_mul_f32 v14, v8, v10
    v_mul_f32 v15, v9, v11
    v_fma_f32 v8, -v14, v12, v8
    v_fma_f32 v9, -v15, v13, v9
    v_max_f32 v8, 0xff7fffff, v8
    v_max_f32 v9, 0xff7fffff, v9
    v_fma_f32 v8, v8, v10, v14
    v_fma_f32 v9, v9, v11, v15
    v_cvt_pk_bf16_f32 v20, v8, v9
    v_and_b32 v9, 0xffff0000, v21
    v_lshlrev_b32 v8, 16, v21
    v_mul_f32 v10, 0xbfb8aa3b, v8
    v_mul_f32 v11, 0xbfb8aa3b, v9
    v_exp_f32 v10, v10
    v_exp_f32 v11, v11
    v_add_f32 v12, 1.0, v10
    v_add_f32 v13, 1.0, v11
    v_rcp_f32 v10, v12
    v_rcp_f32 v11, v13
    v_mul_f32 v14, v8, v10
    v_mul_f32 v15, v9, v11
    v_fma_f32 v8, -v14, v12, v8
    v_fma_f32 v9, -v15, v13, v9
    v_max_f32 v8, 0xff7fffff, v8
    v_max_f32 v9, 0xff7fffff, v9
    v_fma_f32 v8, v8, v10, v14
    v_fma_f32 v9, v9, v11, v15
    v_cvt_pk_bf16_f32 v21, v8, v9
    v_and_b32 v9, 0xffff0000, v22
    v_lshlrev_b32 v8, 16, v22
    v_mul_f32 v10, 0xbfb8aa3b, v8
    v_mul_f32 v11, 0xbfb8aa3b, v9
    v_exp_f32 v10, v10
    v_exp_f32 v11, v11
    v_add_f32 v12, 1.0, v10
    v_add_f32 v13, 1.0, v11
    v_rcp_f32 v10, v12
    v_rcp_f32 v11, v13
    v_mul_f32 v14, v8, v10
    v_mul_f32 v15, v9, v11
    v_fma_f32 v8, -v14, v12, v8
    v_fma_f32 v9, -v15, v13, v9
    v_max_f32 v8, 0xff7fffff, v8
    v_max_f32 v9, 0xff7fffff, v9
    v_fma_f32 v8, v8, v10, v14
    v_fma_f32 v9, v9, v11, v15
    v_cvt_pk_bf16_f32 v22, v8, v9
    v_and_b32 v9, 0xffff0000, v23
    v_lshlrev_b32 v8, 16, v23
    v_mul_f32 v10, 0xbfb8aa3b, v8
    v_mul_f32 v11, 0xbfb8aa3b, v9
    v_exp_f32 v10, v10
    v_exp_f32 v11, v11
    v_add_f32 v12, 1.0, v10
    v_add_f32 v13, 1.0, v11
    v_rcp_f32 v10, v12
    v_rcp_f32 v11, v13
    v_mul_f32 v14, v8, v10
    v_mul_f32 v15, v9, v11
    v_fma_f32 v8, -v14, v12, v8
    v_fma_f32 v9, -v15, v13, v9
    v_max_f32 v8, 0xff7fffff, v8
    v_max_f32 v9, 0xff7fffff, v9
    v_fma_f32 v8, v8, v10, v14
    v_fma_f32 v9, v9, v11, v15
    v_cvt_pk_bf16_f32 v23, v8, v9
    v_and_b32 v9, 0xffff0000, v24
    v_lshlrev_b32 v8, 16, v24
    v_mul_f32 v10, 0xbfb8aa3b, v8
    v_mul_f32 v11, 0xbfb8aa3b, v9
    v_exp_f32 v10, v10
    v_exp_f32 v11, v11
    v_add_f32 v12, 1.0, v10
    v_add_f32 v13, 1.0, v11
    v_rcp_f32 v10, v12
    v_rcp_f32 v11, v13
    v_mul_f32 v14, v8, v10
    v_mul_f32 v15, v9, v11
    v_fma_f32 v8, -v14, v12, v8
    v_fma_f32 v9, -v15, v13, v9
    v_max_f32 v8, 0xff7fffff, v8
    v_max_f32 v9, 0xff7fffff, v9
    v_fma_f32 v8, v8, v10, v14
    v_fma_f32 v9, v9, v11, v15
    v_cvt_pk_bf16_f32 v24, v8, v9
    v_and_b32 v9, 0xffff0000, v25
    v_lshlrev_b32 v8, 16, v25
    v_mul_f32 v10, 0xbfb8aa3b, v8
    v_mul_f32 v11, 0xbfb8aa3b, v9
    v_exp_f32 v10, v10
    v_exp_f32 v11, v11
    v_add_f32 v12, 1.0, v10
    v_add_f32 v13, 1.0, v11
    v_rcp_f32 v10, v12
    v_rcp_f32 v11, v13
    v_mul_f32 v14, v8, v10
    v_mul_f32 v15, v9, v11
    v_fma_f32 v8, -v14, v12, v8
    v_fma_f32 v9, -v15, v13, v9
    v_max_f32 v8, 0xff7fffff, v8
    v_max_f32 v9, 0xff7fffff, v9
    v_fma_f32 v8, v8, v10, v14
    v_fma_f32 v9, v9, v11, v15
    v_cvt_pk_bf16_f32 v25, v8, v9
    v_and_b32 v9, 0xffff0000, v26
    v_lshlrev_b32 v8, 16, v26
    v_mul_f32 v10, 0xbfb8aa3b, v8
    v_mul_f32 v11, 0xbfb8aa3b, v9
    v_exp_f32 v10, v10
    v_exp_f32 v11, v11
    v_add_f32 v12, 1.0, v10
    v_add_f32 v13, 1.0, v11
    v_rcp_f32 v10, v12
    v_rcp_f32 v11, v13
    v_mul_f32 v14, v8, v10
    v_mul_f32 v15, v9, v11
    v_fma_f32 v8, -v14, v12, v8
    v_fma_f32 v9, -v15, v13, v9
    v_max_f32 v8, 0xff7fffff, v8
    v_max_f32 v9, 0xff7fffff, v9
    v_fma_f32 v8, v8, v10, v14
    v_fma_f32 v9, v9, v11, v15
    v_cvt_pk_bf16_f32 v26, v8, v9
    v_and_b32 v9, 0xffff0000, v27
    v_lshlrev_b32 v8, 16, v27
    v_mul_f32 v10, 0xbfb8aa3b, v8
    v_mul_f32 v11, 0xbfb8aa3b, v9
    v_exp_f32 v10, v10
    v_exp_f32 v11, v11
    v_add_f32 v12, 1.0, v10
    v_add_f32 v13, 1.0, v11
    v_rcp_f32 v10, v12
    v_rcp_f32 v11, v13
    v_mul_f32 v14, v8, v10
    v_mul_f32 v15, v9, v11
    v_fma_f32 v8, -v14, v12, v8
    v_fma_f32 v9, -v15, v13, v9
    v_max_f32 v8, 0xff7fffff, v8
    v_max_f32 v9, 0xff7fffff, v9
    v_fma_f32 v8, v8, v10, v14
    v_fma_f32 v9, v9, v11, v15
    v_cvt_pk_bf16_f32 v27, v8, v9
    v_and_b32 v9, 0xffff0000, v28
    v_lshlrev_b32 v8, 16, v28
    v_mul_f32 v10, 0xbfb8aa3b, v8
    v_mul_f32 v11, 0xbfb8aa3b, v9
    v_exp_f32 v10, v10
    v_exp_f32 v11, v11
    v_add_f32 v12, 1.0, v10
    v_add_f32 v13, 1.0, v11
    v_rcp_f32 v10, v12
    v_rcp_f32 v11, v13
    v_mul_f32 v14, v8, v10
    v_mul_f32 v15, v9, v11
    v_fma_f32 v8, -v14, v12, v8
    v_fma_f32 v9, -v15, v13, v9
    v_max_f32 v8, 0xff7fffff, v8
    v_max_f32 v9, 0xff7fffff, v9
    v_fma_f32 v8, v8, v10, v14
    v_fma_f32 v9, v9, v11, v15
    v_cvt_pk_bf16_f32 v28, v8, v9
    ds_write_b32 v30, v20 offset:512
    ds_write_b32 v30, v21 offset:516
    ds_write_b32 v30, v22 offset:520
    ds_write_b32 v30, v23 offset:524
    ds_write_b32 v30, v24 offset:528
    ds_write_b32 v30, v25 offset:532
    ds_write_b32 v30, v26 offset:536
    ds_write_b32 v30, v27 offset:540
    ds_write_b32 v30, v28 offset:544
    v_and_b32 v5, 1, v1
    v_mul_u32_u24 v5, 1152, v5
    v_lshrrev_b32 v4, 4, v1
    v_lshl_add_u32 v5, v4, 4, v5
    v_add_u32 v5, s74, v5
    ds_read_b128 v[56:59], v5 offset:0
    ds_read_b128 v[60:63], v5 offset:64
    ds_read_b128 v[64:67], v5 offset:128
    ds_read_b128 v[68:71], v5 offset:192
    ds_read_b128 v[72:75], v5 offset:256
    ds_read_b128 v[76:79], v5 offset:320
    ds_read_b128 v[80:83], v5 offset:384
    ds_read_b128 v[84:87], v5 offset:448
    ds_read_b128 v[88:91], v5 offset:512
    v_lshrrev_b32 v4, 4, v1
    v_bfe_u32 v5, v1, 2, 2
    v_lshl_add_u32 v5, v4, 3, v5
    v_mul_u32_u24 v5, 128, v5
    v_and_b32 v4, 3, v1
    v_lshl_add_u32 v5, v4, 3, v5
    v_add_u32 v5, 47104, v5
    v_bfe_u32 v4, v1, 2, 2
    v_xor_b32 v6, 0, v4
    v_lshl_add_u32 v92, v6, 5, v5
    v_xor_b32 v6, 1, v4
    v_lshl_add_u32 v93, v6, 5, v5
    v_xor_b32 v6, 2, v4
    v_lshl_add_u32 v94, v6, 5, v5
    v_xor_b32 v6, 3, v4
    v_lshl_add_u32 v95, v6, 5, v5
    s_mov_b32 s69, 0x200000
L_sp_1:
    ds_read_b32 v3, v0 offset:32
    s_waitcnt lgkmcnt(0)
    v_readfirstlane_b32 s70, v3
    s_cmp_eq_u32 s70, 6
    s_cbranch_scc1 L_sd_2
    s_sub_u32 s69, s69, 1
    s_cbranch_scc0 L_sp_1
L_sd_2:
    s_add_u32 s88, s88, 1
    s_and_b32 s89, s88, 7
    ds_read_b64_tr_b16 v[8:9], v92 offset:0
    ds_read_b64_tr_b16 v[10:11], v92 offset:512
    ds_read_b64_tr_b16 v[12:13], v93 offset:0
    ds_read_b64_tr_b16 v[14:15], v93 offset:512
    ds_read_b64_tr_b16 v[16:17], v94 offset:0
    ds_read_b64_tr_b16 v[18:19], v94 offset:512
    ds_read_b64_tr_b16 v[20:21], v95 offset:0
    ds_read_b64_tr_b16 v[22:23], v95 offset:512
    ds_read_b64_tr_b16 v[24:25], v92 offset:4096
    ds_read_b64_tr_b16 v[26:27], v92 offset:4608
    ds_read_b64_tr_b16 v[28:29], v93 offset:4096
    ds_read_b64_tr_b16 v[30:31], v93 offset:4608
    ds_read_b64_tr_b16 v[32:33], v94 offset:4096
    ds_read_b64_tr_b16 v[34:35], v94 offset:4608
    ds_read_b64_tr_b16 v[36:37], v95 offset:4096
    ds_read_b64_tr_b16 v[38:39], v95 offset:4608
    s_waitcnt lgkmcnt(8)
    v_mfma_f32_16x16x32_bf16 v[40:43], v[56:59], v[8:11], 0
    v_mfma_f32_16x16x32_bf16 v[44:47], v[56:59], v[12:15], 0
    v_mfma_f32_16x16x32_bf16 v[48:51], v[56:59], v[16:19], 0
    v_mfma_f32_16x16x32_bf16 v[52:55], v[56:59], v[20:23], 0
    ds_read_b64_tr_b16 v[8:9], v92 offset:8192
    ds_read_b64_tr_b16 v[10:11], v92 offset:8704
    ds_read_b64_tr_b16 v[12:13], v93 offset:8192
    ds_read_b64_tr_b16 v[14:15], v93 offset:8704
    ds_read_b64_tr_b16 v[16:17], v94 offset:8192
    ds_read_b64_tr_b16 v[18:19], v94 offset:8704
    ds_read_b64_tr_b16 v[20:21], v95 offset:8192
    ds_read_b64_tr_b16 v[22:23], v95 offset:8704
    s_waitcnt lgkmcnt(8)
    v_mfma_f32_16x16x32_bf16 v[40:43], v[60:63], v[24:27], v[40:43]
    v_mfma_f32_16x16x32_bf16 v[44:47], v[60:63], v[28:31], v[44:47]
    v_mfma_f32_16x16x32_bf16 v[48:51], v[60:63], v[32:35], v[48:51]
    v_mfma_f32_16x16x32_bf16 v[52:55], v[60:63], v[36:39], v[52:55]
    ds_read_b64_tr_b16 v[24:25], v92 offset:12288
    ds_read_b64_tr_b16 v[26:27], v92 offset:12800
    ds_read_b64_tr_b16 v[28:29], v93 offset:12288
    ds_read_b64_tr_b16 v[30:31], v93 offset:12800
    ds_read_b64_tr_b16 v[32:33], v94 offset:12288
    ds_read_b64_tr_b16 v[34:35], v94 offset:12800
    ds_read_b64_tr_b16 v[36:37], v95 offset:12288
    ds_read_b64_tr_b16 v[38:39], v95 offset:12800
    s_waitcnt lgkmcnt(8)
    v_mfma_f32_16x16x32_bf16 v[40:43], v[64:67], v[8:11], v[40:43]
    v_mfma_f32_16x16x32_bf16 v[44:47], v[64:67], v[12:15], v[44:47]
    v_mfma_f32_16x16x32_bf16 v[48:51], v[64:67], v[16:19], v[48:51]
    v_mfma_f32_16x16x32_bf16 v[52:55], v[64:67], v[20:23], v[52:55]
    ds_read_b64_tr_b16 v[8:9], v92 offset:16384
    ds_read_b64_tr_b16 v[10:11], v92 offset:16896
    ds_read_b64_tr_b16 v[12:13], v93 offset:16384
    ds_read_b64_tr_b16 v[14:15], v93 offset:16896
    ds_read_b64_tr_b16 v[16:17], v94 offset:16384
    ds_read_b64_tr_b16 v[18:19], v94 offset:16896
    ds_read_b64_tr_b16 v[20:21], v95 offset:16384
    ds_read_b64_tr_b16 v[22:23], v95 offset:16896
    s_waitcnt lgkmcnt(8)
    v_mfma_f32_16x16x32_bf16 v[40:43], v[68:71], v[24:27], v[40:43]
    v_mfma_f32_16x16x32_bf16 v[44:47], v[68:71], v[28:31], v[44:47]
    v_mfma_f32_16x16x32_bf16 v[48:51], v[68:71], v[32:35], v[48:51]
    v_mfma_f32_16x16x32_bf16 v[52:55], v[68:71], v[36:39], v[52:55]
    ds_read_b64_tr_b16 v[24:25], v92 offset:20480
    ds_read_b64_tr_b16 v[26:27], v92 offset:20992
    ds_read_b64_tr_b16 v[28:29], v93 offset:20480
    ds_read_b64_tr_b16 v[30:31], v93 offset:20992
    ds_read_b64_tr_b16 v[32:33], v94 offset:20480
    ds_read_b64_tr_b16 v[34:35], v94 offset:20992
    ds_read_b64_tr_b16 v[36:37], v95 offset:20480
    ds_read_b64_tr_b16 v[38:39], v95 offset:20992
    s_waitcnt lgkmcnt(8)
    v_mfma_f32_16x16x32_bf16 v[40:43], v[72:75], v[8:11], v[40:43]
    v_mfma_f32_16x16x32_bf16 v[44:47], v[72:75], v[12:15], v[44:47]
    v_mfma_f32_16x16x32_bf16 v[48:51], v[72:75], v[16:19], v[48:51]
    v_mfma_f32_16x16x32_bf16 v[52:55], v[72:75], v[20:23], v[52:55]
    ds_read_b64_tr_b16 v[8:9], v92 offset:24576
    ds_read_b64_tr_b16 v[10:11], v92 offset:25088
    ds_read_b64_tr_b16 v[12:13], v93 offset:24576
    ds_read_b64_tr_b16 v[14:15], v93 offset:25088
    ds_read_b64_tr_b16 v[16:17], v94 offset:24576
    ds_read_b64_tr_b16 v[18:19], v94 offset:25088
    ds_read_b64_tr_b16 v[20:21], v95 offset:24576
    ds_read_b64_tr_b16 v[22:23], v95 offset:25088
    s_waitcnt lgkmcnt(8)
    v_mfma_f32_16x16x32_bf16 v[40:43], v[76:79], v[24:27], v[40:43]
    v_mfma_f32_16x16x32_bf16 v[44:47], v[76:79], v[28:31], v[44:47]
    v_mfma_f32_16x16x32_bf16 v[48:51], v[76:79], v[32:35], v[48:51]
    v_mfma_f32_16x16x32_bf16 v[52:55], v[76:79], v[36:39], v[52:55]
    ds_read_b64_tr_b16 v[24:25], v92 offset:28672
    ds_read_b64_tr_b16 v[26:27], v92 offset:29184
    ds_read_b64_tr_b16 v[28:29], v93 offset:28672
    ds_read_b64_tr_b16 v[30:31], v93 offset:29184
    ds_read_b64_tr_b16 v[32:33], v94 offset:28672
    ds_read_b64_tr_b16 v[34:35], v94 offset:29184
    ds_read_b64_tr_b16 v[36:37], v95 offset:28672
    ds_read_b64_tr_b16 v[38:39], v95 offset:29184
    s_waitcnt lgkmcnt(8)
    v_mfma_f32_16x16x32_bf16 v[40:43], v[80:83], v[8:11], v[40:43]
    v_mfma_f32_16x16x32_bf16 v[44:47], v[80:83], v[12:15], v[44:47]
    v_mfma_f32_16x16x32_bf16 v[48:51], v[80:83], v[16:19], v[48:51]
    v_mfma_f32_16x16x32_bf16 v[52:55], v[80:83], v[20:23], v[52:55]
    ds_read_b64_tr_b16 v[8:9], v92 offset:32768
    ds_read_b64_tr_b16 v[10:11], v92 offset:33280
    ds_read_b64_tr_b16 v[12:13], v93 offset:32768
    ds_read_b64_tr_b16 v[14:15], v93 offset:33280
    ds_read_b64_tr_b16 v[16:17], v94 offset:32768
    ds_read_b64_tr_b16 v[18:19], v94 offset:33280
    ds_read_b64_tr_b16 v[20:21], v95 offset:32768
    ds_read_b64_tr_b16 v[22:23], v95 offset:33280
    s_waitcnt lgkmcnt(8)
    v_mfma_f32_16x16x32_bf16 v[40:43], v[84:87], v[24:27], v[40:43]
    v_mfma_f32_16x16x32_bf16 v[44:47], v[84:87], v[28:31], v[44:47]
    v_mfma_f32_16x16x32_bf16 v[48:51], v[84:87], v[32:35], v[48:51]
    v_mfma_f32_16x16x32_bf16 v[52:55], v[84:87], v[36:39], v[52:55]
    s_waitcnt lgkmcnt(0)
    v_mfma_f32_16x16x32_bf16 v[40:43], v[88:91], v[8:11], v[40:43]
    v_mfma_f32_16x16x32_bf16 v[44:47], v[88:91], v[12:15], v[44:47]
    v_mfma_f32_16x16x32_bf16 v[48:51], v[88:91], v[16:19], v[48:51]
    v_mfma_f32_16x16x32_bf16 v[52:55], v[88:91], v[20:23], v[52:55]
    s_nop 4
    v_mov_b32 v4, v40
    v_mov_b32_dpp v4, v41 quad_perm:[0,1,2,3] row_mask:0x2 bank_mask:0xf
    v_mov_b32_dpp v4, v44 quad_perm:[0,1,2,3] row_mask:0x4 bank_mask:0xf
    v_mov_b32_dpp v4, v45 quad_perm:[0,1,2,3] row_mask:0x8 bank_mask:0xf
    v_mov_b32 v5, v48
    v_mov_b32_dpp v5, v49 quad_perm:[0,1,2,3] row_mask:0x2 bank_mask:0xf
    v_mov_b32_dpp v5, v52 quad_perm:[0,1,2,3] row_mask:0x4 bank_mask:0xf
    v_mov_b32_dpp v5, v53 quad_perm:[0,1,2,3] row_mask:0x8 bank_mask:0xf
    v_add_u32 v4, 4, v4
    v_bfi_b32 v4, 7, s89, v4
    v_add_u32 v5, 4, v5
    v_bfi_b32 v5, 7, s89, v5
    buffer_store_dword v4, v96, s[12:15], 0 offen sc1
    buffer_store_dword v5, v96, s[12:15], 0 offen offset:128 sc1
    s_sub_u32 s88, s88, 1
L_Adone:
    v_mov_b32 v4, 1
    ds_write_b32 v0, v4 offset:44
    s_setprio 0
    s_mov_b64 vcc, -1
L_stream:
    s_sub_u32 s3, s60, 2
    v_mov_b32 v21, 40
    s_cmp_lt_u32 s3, 12
    s_cbranch_scc0 L_k0
    s_cmp_lt_u32 s3, 6
    s_cbranch_scc0 L_dq
    s_cmp_eq_u32 s67, 1
    s_cbranch_scc0 L_dm
    s_mul_i32 s70, s68, 73728
    s_add_u32 s28, s40, s70
    s_addc_u32 s29, s41, 0
    s_mov_b32 s30, 36864
    s_mov_b32 s31, 0x20000
    s_mul_i32 s76, s3, 6144
    s_add_u32 s75, s76, 47104
    s_mov_b32 s77, 1024
    v_lshlrev_b32 v3, 4, v1
    s_branch L_de
L_dm:
    s_cmp_lt_u32 s95, 108
    s_cbranch_scc0 L_k0
    s_mov_b32 s28, s52
    s_mov_b32 s29, s53
    s_mov_b32 s30, 3981312
    s_mov_b32 s31, 0x20000
    s_mov_b32 s74, 6912
    s_mul_i32 s75, s3, 6144
    s_add_u32 s75, s75, 47104
    s_mul_i32 s76, s3, 48
    s_and_b32 s70, s95, 1
    s_mul_i32 s70, s70, 288
    s_add_u32 s76, s76, s70
    s_mul_i32 s76, s76, 6912
    s_mov_b32 s77, 55296
    v_mov_b32 v21, 32
    v_lshrrev_b32 v3, 3, v1
    v_and_b32 v4, 3, v3
    v_mul_u32_u24 v3, 6912, v3
    v_lshlrev_b32 v4, 1, v4
    v_and_b32 v5, 7, v1
    v_xor_b32 v4, v4, v5
    v_lshl_add_u32 v3, v4, 4, v3
    v_add_u32 v3, s98, v3
    s_branch L_de
L_dq:
    s_mov_b32 s28, s38
    s_mov_b32 s29, s39
    s_mov_b32 s30, 4718592
    s_mov_b32 s31, 0x20000
    s_sub_u32 s70, s3, 6
    s_mov_b32 s74, 8192
    s_mul_i32 s75, s70, 3072
    s_add_u32 s75, s75, 28672
    s_mul_i32 s76, s70, 48
    s_mul_i32 s70, s65, 288
    s_add_u32 s76, s76, s70
    s_mov_b32 s98, s99
    v_mov_b32 v21, 36
L_dd:
    v_lshrrev_b32 v3, 2, v1
    v_mul_u32_u24 v3, s74, v3
    v_and_b32 v4, 3, v1
    v_lshl_add_u32 v3, v4, 4, v3
    v_add_u32 v3, s98, v3
    s_mul_i32 s76, s76, s74
    s_lshl_b32 s77, s74, 4
L_de:
    s_add_u32 m0, s75, 0
    s_nop 0
    buffer_load_dwordx4 v3, s[28:31], s76 offen nt lds
    s_add_u32 s76, s76, s77
    s_add_u32 m0, s75, 1024
    s_nop 0
    buffer_load_dwordx4 v3, s[28:31], s76 offen nt lds
    s_add_u32 s76, s76, s77
    s_add_u32 m0, s75, 2048
    s_nop 0
    buffer_load_dwordx4 v3, s[28:31], s76 offen nt lds
    s_cmp_lt_u32 s3, 6
    s_cbranch_scc0 L_k0
    s_add_u32 s76, s76, s77
    s_add_u32 m0, s75, 3072
    s_nop 0
    buffer_load_dwordx4 v3, s[28:31], s76 offen nt lds
    s_add_u32 s76, s76, s77
    s_add_u32 m0, s75, 4096
    s_nop 0
    buffer_load_dwordx4 v3, s[28:31], s76 offen nt lds
    s_add_u32 s76, s76, s77
    s_add_u32 m0, s75, 5120
    s_nop 0
    buffer_load_dwordx4 v3, s[28:31], s76 offen nt lds
L_k0:
    buffer_load_dwordx4 v[64:67], v2, s[4:7], 0 offen offset:0 nt
    s_cbranch_vccnz L_nb
    s_barrier
L_nb:
    s_waitcnt vmcnt(1)
    v_mov_b32 v22, 1
    s_mov_b64 exec, 1
    ds_add_u32 v21, v22
    s_mov_b64 exec, -1
    buffer_load_dwordx4 v[68:71], v2, s[4:7], 0 offen offset:1024 nt
    s_waitcnt vmcnt(1)
    buffer_load_dwordx4 v[72:75], v2, s[4:7], 0 offen offset:2048 nt
    s_cbranch_vccnz L_sk_3
    s_waitcnt vmcnt(1)
L_sk_3:
    buffer_load_dwordx4 v[76:79], v2, s[4:7], 0 offen offset:3072 nt
    s_waitcnt vmcnt(1)
    buffer_load_dwordx4 v[80:83], v2, s[4:7], s71 offen offset:0 nt
    s_cbranch_vccnz L_sk_4
    s_waitcnt vmcnt(1)
L_sk_4:
    buffer_load_dwordx4 v[84:87], v2, s[4:7], s71 offen offset:1024 nt
    s_waitcnt vmcnt(1)
    buffer_load_dwordx4 v[88:91], v2, s[4:7], s71 offen offset:2048 nt
    s_cbranch_vccnz L_sk_5
    s_waitcnt vmcnt(1)
L_sk_5:
    buffer_load_dwordx4 v[92:95], v2, s[4:7], s71 offen offset:3072 nt
    s_waitcnt vmcnt(1)
    buffer_load_dwordx4 v[96:99], v2, s[4:7], s72 offen offset:0 nt
    s_cbranch_vccnz L_sk_6
    s_waitcnt vmcnt(1)
L_sk_6:
    buffer_load_dwordx4 v[100:103], v2, s[4:7], s72 offen offset:1024 nt
    s_waitcnt vmcnt(1)
    buffer_load_dwordx4 v[104:107], v2, s[4:7], s72 offen offset:2048 nt
    s_cbranch_vccnz L_sk_7
    s_waitcnt vmcnt(1)
L_sk_7:
    buffer_load_dwordx4 v[108:111], v2, s[4:7], s72 offen offset:3072 nt
    s_waitcnt vmcnt(1)
    buffer_load_dwordx4 v[112:115], v2, s[4:7], s73 offen offset:0 nt
    s_cbranch_vccnz L_sk_8
    s_waitcnt vmcnt(1)
L_sk_8:
    buffer_load_dwordx4 v[116:119], v2, s[4:7], s73 offen offset:1024 nt
    s_waitcnt vmcnt(1)
    buffer_load_dwordx4 v[120:123], v2, s[4:7], s73 offen offset:2048 nt
    s_cbranch_vccnz L_sk_9
    s_waitcnt vmcnt(1)
L_sk_9:
    buffer_load_dwordx4 v[124:127], v2, s[4:7], s73 offen offset:3072 nt
    s_waitcnt vmcnt(1)
    buffer_load_dwordx4 v[32:35], v2, s[8:11], 0 offen offset:0 nt
    s_waitcnt vmcnt(1)
    buffer_load_dwordx4 v[36:39], v2, s[8:11], 0 offen offset:1024 nt
    ds_read_b32 v3, v0 offset:0
    s_mov_b32 s86, 2
    s_waitcnt lgkmcnt(0)
    v_readfirstlane_b32 s70, v3
    s_cmp_eq_u32 s70, 1
    s_cbranch_scc1 L_qk
    s_waitcnt vmcnt(1)
    buffer_load_dwordx4 v[40:43], v2, s[8:11], 0 offen offset:2048 nt
    ds_read_b32 v3, v0 offset:0
    s_mov_b32 s86, 3
    s_waitcnt lgkmcnt(0)
    v_readfirstlane_b32 s70, v3
    s_cmp_eq_u32 s70, 1
    s_cbranch_scc1 L_qk
    s_waitcnt vmcnt(1)
    buffer_load_dwordx4 v[44:47], v2, s[8:11], 0 offen offset:3072 nt
    ds_read_b32 v3, v0 offset:0
    s_mov_b32 s86, 4
    s_waitcnt lgkmcnt(0)
    v_readfirstlane_b32 s70, v3
    s_cmp_eq_u32 s70, 1
    s_cbranch_scc1 L_qk
    s_waitcnt vmcnt(1)
    buffer_load_dwordx4 v[48:51], v2, s[8:11], s71 offen offset:0 nt
    ds_read_b32 v3, v0 offset:0
    s_mov_b32 s86, 5
    s_waitcnt lgkmcnt(0)
    v_readfirstlane_b32 s70, v3
    s_cmp_eq_u32 s70, 1
    s_cbranch_scc1 L_qk
    s_waitcnt vmcnt(1)
    buffer_load_dwordx4 v[52:55], v2, s[8:11], s71 offen offset:1024 nt
    ds_read_b32 v3, v0 offset:0
    s_mov_b32 s86, 6
    s_waitcnt lgkmcnt(0)
    v_readfirstlane_b32 s70, v3
    s_cmp_eq_u32 s70, 1
    s_cbranch_scc1 L_qk
    s_waitcnt vmcnt(1)
    buffer_load_dwordx4 v[56:59], v2, s[8:11], s71 offen offset:2048 nt
    ds_read_b32 v3, v0 offset:0
    s_mov_b32 s86, 7
    s_waitcnt lgkmcnt(0)
    v_readfirstlane_b32 s70, v3
    s_cmp_eq_u32 s70, 1
    s_cbranch_scc1 L_qk
    s_waitcnt vmcnt(1)
    buffer_load_dwordx4 v[60:63], v2, s[8:11], s71 offen offset:3072 nt
    s_mov_b32 s86, 8
    s_mov_b32 s69, 0x200000
L_sp_10:
    ds_read_b32 v3, v0 offset:0
    s_waitcnt lgkmcnt(0)
    v_readfirstlane_b32 s70, v3
    s_cmp_eq_u32 s70, 1
    s_cbranch_scc1 L_sd_11
    s_sub_u32 s69, s69, 1
    s_cbranch_scc0 L_sp_10
L_sd_11:
L_qk:
    s_add_u32 s88, s88, 1
    s_and_b32 s89, s88, 7
    v_and_b32 v3, 15, v1
    v_lshlrev_b32 v3, 4, v3
    ds_read_b128 v[4:7], v3 offset:256
    s_waitcnt lgkmcnt(0)
    v_dot2_f32_bf16 v8, v64, v4, 0
    v_dot2_f32_bf16 v8, v65, v5, v8
    v_dot2_f32_bf16 v8, v66, v6, v8
    v_dot2_f32_bf16 v8, v67, v7, v8
    v_dot2_f32_bf16 v9, v68, v4, 0
    v_dot2_f32_bf16 v9, v69, v5, v9
    v_dot2_f32_bf16 v9, v70, v6, v9
    v_dot2_f32_bf16 v9, v71, v7, v9
    v_dot2_f32_bf16 v10, v72, v4, 0
    v_dot2_f32_bf16 v10, v73, v5, v10
    v_dot2_f32_bf16 v10, v74, v6, v10
    v_dot2_f32_bf16 v10, v75, v7, v10
    v_dot2_f32_bf16 v11, v76, v4, 0
    v_dot2_f32_bf16 v11, v77, v5, v11
    v_dot2_f32_bf16 v11, v78, v6, v11
    v_dot2_f32_bf16 v11, v79, v7, v11
    v_dot2_f32_bf16 v12, v80, v4, 0
    v_dot2_f32_bf16 v12, v81, v5, v12
    v_dot2_f32_bf16 v12, v82, v6, v12
    v_dot2_f32_bf16 v12, v83, v7, v12
    v_dot2_f32_bf16 v13, v84, v4, 0
    v_dot2_f32_bf16 v13, v85, v5, v13
    v_dot2_f32_bf16 v13, v86, v6, v13
    v_dot2_f32_bf16 v13, v87, v7, v13
    v_dot2_f32_bf16 v14, v88, v4, 0
    v_dot2_f32_bf16 v14, v89, v5, v14
    v_dot2_f32_bf16 v14, v90, v6, v14
    v_dot2_f32_bf16 v14, v91, v7, v14
    v_dot2_f32_bf16 v15, v92, v4, 0
    v_dot2_f32_bf16 v15, v93, v5, v15
    v_dot2_f32_bf16 v15, v94, v6, v15
    v_dot2_f32_bf16 v15, v95, v7, v15
    v_dot2_f32_bf16 v16, v96, v4, 0
    v_dot2_f32_bf16 v16, v97, v5, v16
    v_dot2_f32_bf16 v16, v98, v6, v16
    v_dot2_f32_bf16 v16, v99, v7, v16
    v_dot2_f32_bf16 v17, v100, v4, 0
    v_dot2_f32_bf16 v17, v101, v5, v17
    v_dot2_f32_bf16 v17, v102, v6, v17
    v_dot2_f32_bf16 v17, v103, v7, v17
    v_dot2_f32_bf16 v18, v104, v4, 0
    v_dot2_f32_bf16 v18, v105, v5, v18
    v_dot2_f32_bf16 v18, v106, v6, v18
    v_dot2_f32_bf16 v18, v107, v7, v18
    v_dot2_f32_bf16 v19, v108, v4, 0
    v_dot2_f32_bf16 v19, v109, v5, v19
    v_dot2_f32_bf16 v19, v110, v6, v19
    v_dot2_f32_bf16 v19, v111, v7, v19
    v_dot2_f32_bf16 v20, v112, v4, 0
    v_dot2_f32_bf16 v20, v113, v5, v20
    v_dot2_f32_bf16 v20, v114, v6, v20
    v_dot2_f32_bf16 v20, v115, v7, v20
    v_dot2_f32_bf16 v21, v116, v4, 0
    v_dot2_f32_bf16 v21, v117, v5, v21
    v_dot2_f32_bf16 v21, v118, v6, v21
    v_dot2_f32_bf16 v21, v119, v7, v21
    v_dot2_f32_bf16 v22, v120, v4, 0
    v_dot2_f32_bf16 v22, v121, v5, v22
    v_dot2_f32_bf16 v22, v122, v6, v22
    v_dot2_f32_bf16 v22, v123, v7, v22
    v_dot2_f32_bf16 v23, v124, v4, 0
    v_dot2_f32_bf16 v23, v125, v5, v23
    v_dot2_f32_bf16 v23, v126, v6, v23
    v_dot2_f32_bf16 v23, v127, v7, v23
    v_add_f32_dpp v24, v8, v8 row_ror:8 row_mask:0xf bank_mask:0x3
    v_add_f32_dpp v24, v16, v16 row_ror:8 row_mask:0xf bank_mask:0xc
    v_add_f32_dpp v25, v9, v9 row_ror:8 row_mask:0xf bank_mask:0x3
    v_add_f32_dpp v25, v17, v17 row_ror:8 row_mask:0xf bank_mask:0xc
    v_add_f32_dpp v26, v10, v10 row_ror:8 row_mask:0xf bank_mask:0x3
    v_add_f32_dpp v26, v18, v18 row_ror:8 row_mask:0xf bank_mask:0xc
    v_add_f32_dpp v27, v11, v11 row_ror:8 row_mask:0xf bank_mask:0x3
    v_add_f32_dpp v27, v19, v19 row_ror:8 row_mask:0xf bank_mask:0xc
    v_add_f32_dpp v28, v12, v12 row_ror:8 row_mask:0xf bank_mask:0x3
    v_add_f32_dpp v28, v20, v20 row_ror:8 row_mask:0xf bank_mask:0xc
    v_add_f32_dpp v29, v13, v13 row_ror:8 row_mask:0xf bank_mask:0x3
    v_add_f32_dpp v29, v21, v21 row_ror:8 row_mask:0xf bank_mask:0xc
    v_add_f32_dpp v30, v14, v14 row_ror:8 row_mask:0xf bank_mask:0x3
    v_add_f32_dpp v30, v22, v22 row_ror:8 row_mask:0xf bank_mask:0xc
    v_add_f32_dpp v31, v15, v15 row_ror:8 row_mask:0xf bank_mask:0x3
    v_add_f32_dpp v31, v23, v23 row_ror:8 row_mask:0xf bank_mask:0xc
    v_add_f32_dpp v8, v24, v24 row_shl:4 row_mask:0xf bank_mask:0x5
    v_add_f32_dpp v8, v28, v28 row_shr:4 row_mask:0xf bank_mask:0xa
    v_add_f32_dpp v9, v25, v25 row_shl:4 row_mask:0xf bank_mask:0x5
    v_add_f32_dpp v9, v29, v29 row_shr:4 row_mask:0xf bank_mask:0xa
    v_add_f32_dpp v10, v26, v26 row_shl:4 row_mask:0xf bank_mask:0x5
    v_add_f32_dpp v10, v30, v30 row_shr:4 row_mask:0xf bank_mask:0xa
    v_add_f32_dpp v11, v27, v27 row_shl:4 row_mask:0xf bank_mask:0x5
    v_add_f32_dpp v11, v31, v31 row_shr:4 row_mask:0xf bank_mask:0xa
    v_add_f32_dpp v12, v8, v8 quad_perm:[2,3,0,1] row_mask:0xf bank_mask:0xf
    v_add_f32_dpp v13, v9, v9 quad_perm:[2,3,0,1] row_mask:0xf bank_mask:0xf
    v_add_f32_dpp v14, v10, v10 quad_perm:[2,3,0,1] row_mask:0xf bank_mask:0xf
    v_add_f32_dpp v15, v11, v11 quad_perm:[2,3,0,1] row_mask:0xf bank_mask:0xf
    v_cndmask_b32 v8, v12, v14, s[90:91]
    v_cndmask_b32 v9, v13, v15, s[90:91]
    s_nop 0
    v_add_f32_dpp v12, v8, v8 quad_perm:[1,0,3,2] row_mask:0xf bank_mask:0xf
    v_add_f32_dpp v13, v9, v9 quad_perm:[1,0,3,2] row_mask:0xf bank_mask:0xf
    v_cndmask_b32 v16, v12, v13, s[92:93]
    v_cvt_pk_bf16_f32 v16, v16, v16
    v_and_b32 v16, 0xffff0000, v16
    v_mul_f32 v16, 0x3db504f3, v16
    v_cvt_pk_bf16_f32 v16, v16, v16
    v_and_b32 v16, 0xffff0000, v16
    v_mov_b32 v8, v16
    s_nop 1
    v_max_f32_dpp v8, v8, v8 row_ror:8 row_mask:0xf bank_mask:0xf
    s_nop 1
    v_max_f32_dpp v8, v8, v8 row_ror:4 row_mask:0xf bank_mask:0xf
    s_nop 1
    v_max_f32_dpp v8, v8, v8 row_ror:2 row_mask:0xf bank_mask:0xf
    s_nop 1
    v_max_f32_dpp v8, v8, v8 row_ror:1 row_mask:0xf bank_mask:0xf
    v_mov_b32 v9, v8
    s_nop 1
    v_permlane16_swap_b32 v8, v9
    v_max_f32 v8, v8, v9
    v_mov_b32 v9, v8
    s_nop 1
    v_permlane32_swap_b32 v8, v9
    v_max_f32 v8, v8, v9
    v_sub_f32 v9, v16, v8
    v_mul_f32 v9, 1069066811, v9
    v_exp_f32 v9, v9
    s_nop 1
    v_add_f32_dpp v9, v9, v9 row_ror:8 row_mask:0xf bank_mask:0xf
    s_nop 1
    v_add_f32_dpp v9, v9, v9 row_ror:4 row_mask:0xf bank_mask:0xf
    s_nop 1
    v_add_f32_dpp v9, v9, v9 row_ror:2 row_mask:0xf bank_mask:0xf
    s_nop 1
    v_add_f32_dpp v9, v9, v9 row_ror:1 row_mask:0xf bank_mask:0xf
    v_mov_b32 v10, v9
    s_nop 1
    v_permlane16_swap_b32 v9, v10
    v_add_f32 v9, v9, v10
    v_mov_b32 v10, v9
    s_nop 1
    v_permlane32_swap_b32 v9, v10
    v_add_f32 v9, v9, v10
    s_lshl_b32 s70, s60, 3
    v_mov_b32 v10, s70
    v_mov_b32 v11, 1
    s_mov_b64 exec, 1
    ds_write_b64 v10, v[8:9] offset:64
    ds_add_u32 v0, v11 offset:4
    s_mov_b64 exec, -1
    s_mov_b32 s16, s40
    s_mov_b32 s17, s41
    s_mov_b32 s18, 0
    s_mov_b32 s19, 0x20000
    s_mov_b32 s20, s40
    s_mov_b32 s21, s41
    s_mov_b32 s22, 0
    s_mov_b32 s23, 0x20000
    s_mov_b32 s24, s40
    s_mov_b32 s25, s41
    s_mov_b32 s26, 0
    s_mov_b32 s27, 0x20000
    s_sub_u32 s3, s60, 2
    s_mul_i32 s70, s3, 3072
    v_lshl_add_u32 v21, v1, 4, s70
    v_mov_b32 v20, v21
    s_mov_b32 s74, 1024
    s_mov_b32 s76, 1024
    s_mov_b32 s77, 2048
    s_mov_b32 s78, 28672
    s_mov_b32 s79, 0
    s_cmp_lt_u32 s3, 12
    s_cbranch_scc0 L_wset
    s_add_u32 s78, s70, 47104
    s_mov_b32 s79, 36864
    s_cmp_eq_u32 s67, 1
    s_cbranch_scc0 L_wF
    s_mul_i32 s70, s68, 73728
    s_add_u32 s16, s40, s70
    s_addc_u32 s17, s41, 0
    s_mov_b32 s18, 36864
    s_mov_b32 s19, 0x20000
    s_add_u32 s70, s70, 36864
    s_add_u32 s20, s40, s70
    s_addc_u32 s21, s41, 0
    s_mov_b32 s22, 36864
    s_mov_b32 s23, 0x20000
L_wF:
    s_cmp_eq_u32 s67, 3
    s_cbranch_scc0 L_wset
    s_mov_b32 s16, s44
    s_mov_b32 s17, s45
    s_mov_b32 s18, 5308416
    s_mov_b32 s19, 0x20000
    s_mov_b32 s20, s46
    s_mov_b32 s21, s47
    s_mov_b32 s22, 5308416
    s_mov_b32 s23, 0x20000
    s_mul_i32 s70, s68, 36864
    s_add_u32 s24, s48, s70
    s_addc_u32 s25, s49, 0
    s_mov_b32 s26, 36864
    s_mov_b32 s27, 0x20000
    s_mul_i32 s70, s3, 442368
    s_lshl_b32 s3, s68, 6
    s_add_u32 s70, s70, s3
    v_lshrrev_b32 v20, 2, v1
    v_mul_u32_u24 v20, 9216, v20
    v_and_b32 v22, 3, v1
    v_lshl_add_u32 v20, v22, 4, v20
    v_add_u32 v20, s70, v20
    s_mov_b32 s74, 147456
L_wset:
    s_lshl_b32 s75, s74, 1
    s_cmp_eq_u32 s86, 3
    s_cbranch_scc1 L_v3
    s_cmp_eq_u32 s86, 4
    s_cbranch_scc1 L_v4
    s_cmp_eq_u32 s86, 5
    s_cbranch_scc1 L_v5
    s_cmp_eq_u32 s86, 6
    s_cbranch_scc1 L_v6
    s_cmp_eq_u32 s86, 7
    s_cbranch_scc1 L_v7
    s_cmp_eq_u32 s86, 8
    s_cbranch_scc1 L_v8
L_v2:
    s_waitcnt vmcnt(2)
    buffer_load_dwordx4 v[40:43], v2, s[8:11], 0 offen offset:2048 nt
L_v3:
    s_waitcnt vmcnt(2)
    buffer_load_dwordx4 v[44:47], v2, s[8:11], 0 offen offset:3072 nt
L_v4:
    s_waitcnt vmcnt(2)
    buffer_load_dwordx4 v[48:51], v2, s[8:11], s71 offen offset:0 nt
L_v5:
    s_waitcnt vmcnt(2)
    buffer_load_dwordx4 v[52:55], v2, s[8:11], s71 offen offset:1024 nt
L_v6:
    s_waitcnt vmcnt(2)
    buffer_load_dwordx4 v[56:59], v2, s[8:11], s71 offen offset:2048 nt
L_v7:
    s_waitcnt vmcnt(2)
    buffer_load_dwordx4 v[60:63], v2, s[8:11], s71 offen offset:3072 nt
L_v8:
    s_waitcnt vmcnt(2)
    buffer_load_dwordx4 v[64:67], v2, s[8:11], s72 offen offset:0 nt
    s_waitcnt vmcnt(2)
    buffer_load_dwordx4 v[68:71], v2, s[8:11], s72 offen offset:1024 nt
    s_waitcnt vmcnt(2)
    buffer_load_dwordx4 v[72:75], v2, s[8:11], s72 offen offset:2048 nt
    s_waitcnt vmcnt(2)
    buffer_load_dwordx4 v[76:79], v2, s[8:11], s72 offen offset:3072 nt
    s_waitcnt vmcnt(2)
    buffer_load_dwordx4 v[80:83], v2, s[8:11], s73 offen offset:0 nt
    s_waitcnt vmcnt(2)
    buffer_load_dwordx4 v[84:87], v2, s[8:11], s73 offen offset:1024 nt
    s_waitcnt vmcnt(2)
    buffer_load_dwordx4 v[88:91], v2, s[8:11], s73 offen offset:2048 nt
    s_waitcnt vmcnt(2)
    buffer_load_dwordx4 v[92:95], v2, s[8:11], s73 offen offset:3072 nt
    s_mov_b32 s69, 0x200000
L_sp_12:
    ds_read_b32 v3, v0 offset:8
    s_waitcnt lgkmcnt(0)
    v_readfirstlane_b32 s70, v3
    s_cmp_eq_u32 s70, 1
    s_cbranch_scc1 L_sd_13
    s_sub_u32 s69, s69, 1
    s_cbranch_scc0 L_sp_12
L_sd_13:
L_e16:
    ds_read_b64 v[8:9], v0 offset:16
    s_waitcnt lgkmcnt(0)
    v_sub_f32 v10, v16, v8
    v_mul_f32 v10, 1069066811, v10
    v_exp_f32 v10, v10
    s_nop 0
    v_mul_f32 v10, v10, v9
    v_cvt_pk_bf16_f32 v17, v10, 0
    v_lshlrev_b32 v18, 16, v17
    v_mov_b32 v8, 0
    v_mov_b32 v9, 0
    v_mov_b32 v10, 0
    v_mov_b32 v11, 0
    v_mov_b32 v12, 0
    v_mov_b32 v13, 0
    v_mov_b32 v14, 0
    v_mov_b32 v15, 0
    s_waitcnt vmcnt(15)
    v_dot2c_f32_bf16_dpp v8, v17, v32 row_newbcast:0 row_mask:0xf bank_mask:0xf
    v_dot2c_f32_bf16_dpp v9, v18, v32 row_newbcast:0 row_mask:0xf bank_mask:0xf
    v_dot2c_f32_bf16_dpp v10, v17, v33 row_newbcast:0 row_mask:0xf bank_mask:0xf
    v_dot2c_f32_bf16_dpp v11, v18, v33 row_newbcast:0 row_mask:0xf bank_mask:0xf
    v_dot2c_f32_bf16_dpp v12, v17, v34 row_newbcast:0 row_mask:0xf bank_mask:0xf
    v_dot2c_f32_bf16_dpp v13, v18, v34 row_newbcast:0 row_mask:0xf bank_mask:0xf
    v_dot2c_f32_bf16_dpp v14, v17, v35 row_newbcast:0 row_mask:0xf bank_mask:0xf
    v_dot2c_f32_bf16_dpp v15, v18, v35 row_newbcast:0 row_mask:0xf bank_mask:0xf
    s_waitcnt vmcnt(14)
    v_dot2c_f32_bf16_dpp v8, v17, v36 row_newbcast:1 row_mask:0xf bank_mask:0xf
    v_dot2c_f32_bf16_dpp v9, v18, v36 row_newbcast:1 row_mask:0xf bank_mask:0xf
    v_dot2c_f32_bf16_dpp v10, v17, v37 row_newbcast:1 row_mask:0xf bank_mask:0xf
    v_dot2c_f32_bf16_dpp v11, v18, v37 row_newbcast:1 row_mask:0xf bank_mask:0xf
    v_dot2c_f32_bf16_dpp v12, v17, v38 row_newbcast:1 row_mask:0xf bank_mask:0xf
    v_dot2c_f32_bf16_dpp v13, v18, v38 row_newbcast:1 row_mask:0xf bank_mask:0xf
    v_dot2c_f32_bf16_dpp v14, v17, v39 row_newbcast:1 row_mask:0xf bank_mask:0xf
    v_dot2c_f32_bf16_dpp v15, v18, v39 row_newbcast:1 row_mask:0xf bank_mask:0xf
    s_waitcnt vmcnt(13)
    v_dot2c_f32_bf16_dpp v8, v17, v40 row_newbcast:2 row_mask:0xf bank_mask:0xf
    v_dot2c_f32_bf16_dpp v9, v18, v40 row_newbcast:2 row_mask:0xf bank_mask:0xf
    v_dot2c_f32_bf16_dpp v10, v17, v41 row_newbcast:2 row_mask:0xf bank_mask:0xf
    v_dot2c_f32_bf16_dpp v11, v18, v41 row_newbcast:2 row_mask:0xf bank_mask:0xf
    v_dot2c_f32_bf16_dpp v12, v17, v42 row_newbcast:2 row_mask:0xf bank_mask:0xf
    v_dot2c_f32_bf16_dpp v13, v18, v42 row_newbcast:2 row_mask:0xf bank_mask:0xf
    v_dot2c_f32_bf16_dpp v14, v17, v43 row_newbcast:2 row_mask:0xf bank_mask:0xf
    v_dot2c_f32_bf16_dpp v15, v18, v43 row_newbcast:2 row_mask:0xf bank_mask:0xf
    s_waitcnt vmcnt(12)
    v_dot2c_f32_bf16_dpp v8, v17, v44 row_newbcast:3 row_mask:0xf bank_mask:0xf
    v_dot2c_f32_bf16_dpp v9, v18, v44 row_newbcast:3 row_mask:0xf bank_mask:0xf
    v_dot2c_f32_bf16_dpp v10, v17, v45 row_newbcast:3 row_mask:0xf bank_mask:0xf
    v_dot2c_f32_bf16_dpp v11, v18, v45 row_newbcast:3 row_mask:0xf bank_mask:0xf
    v_dot2c_f32_bf16_dpp v12, v17, v46 row_newbcast:3 row_mask:0xf bank_mask:0xf
    v_dot2c_f32_bf16_dpp v13, v18, v46 row_newbcast:3 row_mask:0xf bank_mask:0xf
    v_dot2c_f32_bf16_dpp v14, v17, v47 row_newbcast:3 row_mask:0xf bank_mask:0xf
    v_dot2c_f32_bf16_dpp v15, v18, v47 row_newbcast:3 row_mask:0xf bank_mask:0xf
    s_waitcnt vmcnt(11)
    v_dot2c_f32_bf16_dpp v8, v17, v48 row_newbcast:4 row_mask:0xf bank_mask:0xf
    v_dot2c_f32_bf16_dpp v9, v18, v48 row_newbcast:4 row_mask:0xf bank_mask:0xf
    v_dot2c_f32_bf16_dpp v10, v17, v49 row_newbcast:4 row_mask:0xf bank_mask:0xf
    v_dot2c_f32_bf16_dpp v11, v18, v49 row_newbcast:4 row_mask:0xf bank_mask:0xf
    v_dot2c_f32_bf16_dpp v12, v17, v50 row_newbcast:4 row_mask:0xf bank_mask:0xf
    v_dot2c_f32_bf16_dpp v13, v18, v50 row_newbcast:4 row_mask:0xf bank_mask:0xf
    v_dot2c_f32_bf16_dpp v14, v17, v51 row_newbcast:4 row_mask:0xf bank_mask:0xf
    v_dot2c_f32_bf16_dpp v15, v18, v51 row_newbcast:4 row_mask:0xf bank_mask:0xf
    s_waitcnt vmcnt(10)
    v_dot2c_f32_bf16_dpp v8, v17, v52 row_newbcast:5 row_mask:0xf bank_mask:0xf
    v_dot2c_f32_bf16_dpp v9, v18, v52 row_newbcast:5 row_mask:0xf bank_mask:0xf
    v_dot2c_f32_bf16_dpp v10, v17, v53 row_newbcast:5 row_mask:0xf bank_mask:0xf
    v_dot2c_f32_bf16_dpp v11, v18, v53 row_newbcast:5 row_mask:0xf bank_mask:0xf
    v_dot2c_f32_bf16_dpp v12, v17, v54 row_newbcast:5 row_mask:0xf bank_mask:0xf
    v_dot2c_f32_bf16_dpp v13, v18, v54 row_newbcast:5 row_mask:0xf bank_mask:0xf
    v_dot2c_f32_bf16_dpp v14, v17, v55 row_newbcast:5 row_mask:0xf bank_mask:0xf
    v_dot2c_f32_bf16_dpp v15, v18, v55 row_newbcast:5 row_mask:0xf bank_mask:0xf
    s_waitcnt vmcnt(9)
    v_dot2c_f32_bf16_dpp v8, v17, v56 row_newbcast:6 row_mask:0xf bank_mask:0xf
    v_dot2c_f32_bf16_dpp v9, v18, v56 row_newbcast:6 row_mask:0xf bank_mask:0xf
    v_dot2c_f32_bf16_dpp v10, v17, v57 row_newbcast:6 row_mask:0xf bank_mask:0xf
    v_dot2c_f32_bf16_dpp v11, v18, v57 row_newbcast:6 row_mask:0xf bank_mask:0xf
    v_dot2c_f32_bf16_dpp v12, v17, v58 row_newbcast:6 row_mask:0xf bank_mask:0xf
    v_dot2c_f32_bf16_dpp v13, v18, v58 row_newbcast:6 row_mask:0xf bank_mask:0xf
    v_dot2c_f32_bf16_dpp v14, v17, v59 row_newbcast:6 row_mask:0xf bank_mask:0xf
    v_dot2c_f32_bf16_dpp v15, v18, v59 row_newbcast:6 row_mask:0xf bank_mask:0xf
    s_waitcnt vmcnt(8)
    v_dot2c_f32_bf16_dpp v8, v17, v60 row_newbcast:7 row_mask:0xf bank_mask:0xf
    v_dot2c_f32_bf16_dpp v9, v18, v60 row_newbcast:7 row_mask:0xf bank_mask:0xf
    v_dot2c_f32_bf16_dpp v10, v17, v61 row_newbcast:7 row_mask:0xf bank_mask:0xf
    v_dot2c_f32_bf16_dpp v11, v18, v61 row_newbcast:7 row_mask:0xf bank_mask:0xf
    v_dot2c_f32_bf16_dpp v12, v17, v62 row_newbcast:7 row_mask:0xf bank_mask:0xf
    v_dot2c_f32_bf16_dpp v13, v18, v62 row_newbcast:7 row_mask:0xf bank_mask:0xf
    v_dot2c_f32_bf16_dpp v14, v17, v63 row_newbcast:7 row_mask:0xf bank_mask:0xf
    v_dot2c_f32_bf16_dpp v15, v18, v63 row_newbcast:7 row_mask:0xf bank_mask:0xf
    s_waitcnt vmcnt(7)
    v_dot2c_f32_bf16_dpp v8, v17, v64 row_newbcast:8 row_mask:0xf bank_mask:0xf
    v_dot2c_f32_bf16_dpp v9, v18, v64 row_newbcast:8 row_mask:0xf bank_mask:0xf
    v_dot2c_f32_bf16_dpp v10, v17, v65 row_newbcast:8 row_mask:0xf bank_mask:0xf
    v_dot2c_f32_bf16_dpp v11, v18, v65 row_newbcast:8 row_mask:0xf bank_mask:0xf
    v_dot2c_f32_bf16_dpp v12, v17, v66 row_newbcast:8 row_mask:0xf bank_mask:0xf
    v_dot2c_f32_bf16_dpp v13, v18, v66 row_newbcast:8 row_mask:0xf bank_mask:0xf
    v_dot2c_f32_bf16_dpp v14, v17, v67 row_newbcast:8 row_mask:0xf bank_mask:0xf
    v_dot2c_f32_bf16_dpp v15, v18, v67 row_newbcast:8 row_mask:0xf bank_mask:0xf
    s_waitcnt vmcnt(6)
    v_dot2c_f32_bf16_dpp v8, v17, v68 row_newbcast:9 row_mask:0xf bank_mask:0xf
    v_dot2c_f32_bf16_dpp v9, v18, v68 row_newbcast:9 row_mask:0xf bank_mask:0xf
    v_dot2c_f32_bf16_dpp v10, v17, v69 row_newbcast:9 row_mask:0xf bank_mask:0xf
    v_dot2c_f32_bf16_dpp v11, v18, v69 row_newbcast:9 row_mask:0xf bank_mask:0xf
    v_dot2c_f32_bf16_dpp v12, v17, v70 row_newbcast:9 row_mask:0xf bank_mask:0xf
    v_dot2c_f32_bf16_dpp v13, v18, v70 row_newbcast:9 row_mask:0xf bank_mask:0xf
    v_dot2c_f32_bf16_dpp v14, v17, v71 row_newbcast:9 row_mask:0xf bank_mask:0xf
    v_dot2c_f32_bf16_dpp v15, v18, v71 row_newbcast:9 row_mask:0xf bank_mask:0xf
    s_waitcnt vmcnt(5)
    v_dot2c_f32_bf16_dpp v8, v17, v72 row_newbcast:10 row_mask:0xf bank_mask:0xf
    v_dot2c_f32_bf16_dpp v9, v18, v72 row_newbcast:10 row_mask:0xf bank_mask:0xf
    v_dot2c_f32_bf16_dpp v10, v17, v73 row_newbcast:10 row_mask:0xf bank_mask:0xf
    v_dot2c_f32_bf16_dpp v11, v18, v73 row_newbcast:10 row_mask:0xf bank_mask:0xf
    v_dot2c_f32_bf16_dpp v12, v17, v74 row_newbcast:10 row_mask:0xf bank_mask:0xf
    v_dot2c_f32_bf16_dpp v13, v18, v74 row_newbcast:10 row_mask:0xf bank_mask:0xf
    v_dot2c_f32_bf16_dpp v14, v17, v75 row_newbcast:10 row_mask:0xf bank_mask:0xf
    v_dot2c_f32_bf16_dpp v15, v18, v75 row_newbcast:10 row_mask:0xf bank_mask:0xf
    s_waitcnt vmcnt(4)
    v_dot2c_f32_bf16_dpp v8, v17, v76 row_newbcast:11 row_mask:0xf bank_mask:0xf
    v_dot2c_f32_bf16_dpp v9, v18, v76 row_newbcast:11 row_mask:0xf bank_mask:0xf
    v_dot2c_f32_bf16_dpp v10, v17, v77 row_newbcast:11 row_mask:0xf bank_mask:0xf
    v_dot2c_f32_bf16_dpp v11, v18, v77 row_newbcast:11 row_mask:0xf bank_mask:0xf
    v_dot2c_f32_bf16_dpp v12, v17, v78 row_newbcast:11 row_mask:0xf bank_mask:0xf
    v_dot2c_f32_bf16_dpp v13, v18, v78 row_newbcast:11 row_mask:0xf bank_mask:0xf
    v_dot2c_f32_bf16_dpp v14, v17, v79 row_newbcast:11 row_mask:0xf bank_mask:0xf
    v_dot2c_f32_bf16_dpp v15, v18, v79 row_newbcast:11 row_mask:0xf bank_mask:0xf
    s_waitcnt vmcnt(3)
    v_dot2c_f32_bf16_dpp v8, v17, v80 row_newbcast:12 row_mask:0xf bank_mask:0xf
    v_dot2c_f32_bf16_dpp v9, v18, v80 row_newbcast:12 row_mask:0xf bank_mask:0xf
    v_dot2c_f32_bf16_dpp v10, v17, v81 row_newbcast:12 row_mask:0xf bank_mask:0xf
    v_dot2c_f32_bf16_dpp v11, v18, v81 row_newbcast:12 row_mask:0xf bank_mask:0xf
    v_dot2c_f32_bf16_dpp v12, v17, v82 row_newbcast:12 row_mask:0xf bank_mask:0xf
    v_dot2c_f32_bf16_dpp v13, v18, v82 row_newbcast:12 row_mask:0xf bank_mask:0xf
    v_dot2c_f32_bf16_dpp v14, v17, v83 row_newbcast:12 row_mask:0xf bank_mask:0xf
    v_dot2c_f32_bf16_dpp v15, v18, v83 row_newbcast:12 row_mask:0xf bank_mask:0xf
    s_waitcnt vmcnt(2)
    v_dot2c_f32_bf16_dpp v8, v17, v84 row_newbcast:13 row_mask:0xf bank_mask:0xf
    v_dot2c_f32_bf16_dpp v9, v18, v84 row_newbcast:13 row_mask:0xf bank_mask:0xf
    v_dot2c_f32_bf16_dpp v10, v17, v85 row_newbcast:13 row_mask:0xf bank_mask:0xf
    v_dot2c_f32_bf16_dpp v11, v18, v85 row_newbcast:13 row_mask:0xf bank_mask:0xf
    v_dot2c_f32_bf16_dpp v12, v17, v86 row_newbcast:13 row_mask:0xf bank_mask:0xf
    v_dot2c_f32_bf16_dpp v13, v18, v86 row_newbcast:13 row_mask:0xf bank_mask:0xf
    v_dot2c_f32_bf16_dpp v14, v17, v87 row_newbcast:13 row_mask:0xf bank_mask:0xf
    v_dot2c_f32_bf16_dpp v15, v18, v87 row_newbcast:13 row_mask:0xf bank_mask:0xf
    s_waitcnt vmcnt(1)
    v_dot2c_f32_bf16_dpp v8, v17, v88 row_newbcast:14 row_mask:0xf bank_mask:0xf
    v_dot2c_f32_bf16_dpp v9, v18, v88 row_newbcast:14 row_mask:0xf bank_mask:0xf
    v_dot2c_f32_bf16_dpp v10, v17, v89 row_newbcast:14 row_mask:0xf bank_mask:0xf
    v_dot2c_f32_bf16_dpp v11, v18, v89 row_newbcast:14 row_mask:0xf bank_mask:0xf
    v_dot2c_f32_bf16_dpp v12, v17, v90 row_newbcast:14 row_mask:0xf bank_mask:0xf
    v_dot2c_f32_bf16_dpp v13, v18, v90 row_newbcast:14 row_mask:0xf bank_mask:0xf
    v_dot2c_f32_bf16_dpp v14, v17, v91 row_newbcast:14 row_mask:0xf bank_mask:0xf
    v_dot2c_f32_bf16_dpp v15, v18, v91 row_newbcast:14 row_mask:0xf bank_mask:0xf
    s_waitcnt vmcnt(0)
    v_dot2c_f32_bf16_dpp v8, v17, v92 row_newbcast:15 row_mask:0xf bank_mask:0xf
    v_dot2c_f32_bf16_dpp v9, v18, v92 row_newbcast:15 row_mask:0xf bank_mask:0xf
    v_dot2c_f32_bf16_dpp v10, v17, v93 row_newbcast:15 row_mask:0xf bank_mask:0xf
    v_dot2c_f32_bf16_dpp v11, v18, v93 row_newbcast:15 row_mask:0xf bank_mask:0xf
    v_dot2c_f32_bf16_dpp v12, v17, v94 row_newbcast:15 row_mask:0xf bank_mask:0xf
    v_dot2c_f32_bf16_dpp v13, v18, v94 row_newbcast:15 row_mask:0xf bank_mask:0xf
    v_dot2c_f32_bf16_dpp v14, v17, v95 row_newbcast:15 row_mask:0xf bank_mask:0xf
    v_dot2c_f32_bf16_dpp v15, v18, v95 row_newbcast:15 row_mask:0xf bank_mask:0xf
    v_permlane32_swap_b32 v8, v12
    v_permlane32_swap_b32 v9, v13
    v_permlane32_swap_b32 v10, v14
    v_permlane32_swap_b32 v11, v15
    v_add_f32 v8, v8, v12
    v_add_f32 v9, v9, v13
    v_add_f32 v10, v10, v14
    v_add_f32 v11, v11, v15
    s_nop 0
    v_permlane16_swap_b32 v8, v10
    v_permlane16_swap_b32 v9, v11
    v_add_f32 v8, v8, v10
    v_add_f32 v9, v9, v11
    v_and_b32 v10, 15, v1
    v_lshrrev_b32 v11, 4, v1
    v_lshlrev_b32 v10, 5, v10
    v_lshl_add_u32 v10, v11, 3, v10
    s_lshl_b32 s70, s60, 9
    v_add_u32 v10, s70, v10
    v_mov_b32 v11, 1
    ds_write_b64 v10, v[8:9] offset:10240
    s_mov_b64 exec, 1
    ds_add_u32 v0, v11 offset:12
    s_mov_b64 exec, -1
    s_lshl_b32 s3, s67, 4
    s_add_u32 s3, s3, s60
    s_sub_u32 s3, s3, 34
    s_cmp_lt_u32 s3, 3
    s_cbranch_scc1 L_R
    s_bitcmp1_b32 s67, 0
    s_cbranch_scc0 L_sx
    s_sub_u32 s95, s60, 2
    s_cmp_lt_u32 s95, 12
    s_cbranch_scc1 L_dw
    s_cmp_eq_u32 s67, 3
    s_cbranch_scc0 L_sx
    s_cmp_ge_u32 s60, 14
    s_cbranch_scc1 L_LN
L_sx:
    s_endpgm
L_dw:
    s_cmp_eq_u32 s67, 1
    s_cbranch_scc1 L_nw
    s_mov_b32 s69, 0x200000
L_sp_14:
    ds_read_b32 v3, v0 offset:12
    s_waitcnt lgkmcnt(0)
    v_readfirstlane_b32 s70, v3
    s_cmp_eq_u32 s70, 16
    s_cbranch_scc1 L_sd_15
    s_sub_u32 s69, s69, 1
    s_cbranch_scc0 L_sp_14
L_sd_15:
L_nw:
    s_cmp_eq_u32 s67, 3
    s_cbranch_scc1 L_d0
    s_add_u32 s78, s78, s79
    s_branch L_d3
L_d0:
    s_waitcnt vmcnt(3)
    s_add_u32 m0, s78, 0
    s_nop 0
    buffer_load_dwordx4 v20, s[16:19], 0 offen nt lds
    s_waitcnt vmcnt(3)
    s_add_u32 m0, s78, 1024
    s_nop 0
    buffer_load_dwordx4 v20, s[16:19], s74 offen nt lds
    s_waitcnt vmcnt(3)
    s_add_u32 m0, s78, 2048
    s_nop 0
    buffer_load_dwordx4 v20, s[16:19], s75 offen nt lds
    s_add_u32 s78, s78, s79
L_d3:
    s_waitcnt vmcnt(3)
    s_add_u32 m0, s78, 0
    s_nop 0
    buffer_load_dwordx4 v20, s[20:23], 0 offen nt lds
    s_waitcnt vmcnt(3)
    s_add_u32 m0, s78, 1024
    s_nop 0
    buffer_load_dwordx4 v20, s[20:23], s74 offen nt lds
    s_waitcnt vmcnt(3)
    s_add_u32 m0, s78, 2048
    s_nop 0
    buffer_load_dwordx4 v20, s[20:23], s75 offen nt lds
    s_add_u32 s78, s78, s79
    s_cmp_eq_u32 s67, 3
    s_cbranch_scc0 L_d9
    s_waitcnt vmcnt(3)
    s_add_u32 m0, s78, 0
    s_nop 0
    buffer_load_dwordx4 v21, s[24:27], 0 offen nt lds
    s_waitcnt vmcnt(3)
    s_add_u32 m0, s78, 1024
    s_nop 0
    buffer_load_dwordx4 v21, s[24:27], s76 offen nt lds
    s_waitcnt vmcnt(3)
    s_add_u32 m0, s78, 2048
    s_nop 0
    buffer_load_dwordx4 v21, s[24:27], s77 offen nt lds
    s_waitcnt vmcnt(3)
    s_branch L_d10
L_d9:
    s_waitcnt vmcnt(0)
L_d10:
    v_mov_b32 v22, 1
    s_mov_b64 exec, 1
    ds_add_u32 v0, v22 offset:24
    s_mov_b64 exec, -1
    s_cmp_eq_u32 s67, 3
    s_cbranch_scc1 L_F
    s_sub_u32 s3, s60, 2
    s_cmp_lt_u32 s3, 9
    s_cbranch_scc0 L_end
    s_lshl_b32 s3, s3, 7
    s_add_u32 s3, s3, 47104
    v_lshrrev_b32 v4, 4, v1
    v_bfe_u32 v5, v1, 2, 2
    v_lshl_add_u32 v5, v4, 3, v5
    v_mul_u32_u24 v5, 1152, v5
    v_and_b32 v4, 3, v1
    v_lshl_add_u32 v5, v4, 3, v5
    v_add_u32 v5, s3, v5
    v_and_b32 v27, 1, v1
    v_mul_u32_u24 v27, 128, v27
    v_lshrrev_b32 v4, 4, v1
    v_lshl_add_u32 v27, v4, 4, v27
    v_add_u32 v27, 5120, v27
    s_mul_i32 s70, s68, 4608
    s_lshl_b32 s3, s60, 8
    s_add_u32 s70, s70, s3
    s_add_u32 s70, s70, 261632
    v_lshl_add_u32 v26, v1, 2, s70
    s_mov_b32 s69, 0x200000
L_sp_16:
    ds_read_b32 v3, v0 offset:24
    s_waitcnt lgkmcnt(0)
    v_readfirstlane_b32 s70, v3
    s_cmp_eq_u32 s70, 12
    s_cbranch_scc1 L_sd_17
    s_sub_u32 s69, s69, 1
    s_cbranch_scc0 L_sp_16
L_sd_17:
    ds_read_b64_tr_b16 v[32:33], v5 offset:0
    ds_read_b64_tr_b16 v[34:35], v5 offset:4608
    ds_read_b64_tr_b16 v[36:37], v5 offset:36864
    ds_read_b64_tr_b16 v[38:39], v5 offset:41472
    ds_read_b64_tr_b16 v[40:41], v5 offset:32
    ds_read_b64_tr_b16 v[42:43], v5 offset:4640
    ds_read_b64_tr_b16 v[44:45], v5 offset:36896
    ds_read_b64_tr_b16 v[46:47], v5 offset:41504
    ds_read_b64_tr_b16 v[48:49], v5 offset:64
    ds_read_b64_tr_b16 v[50:51], v5 offset:4672
    ds_read_b64_tr_b16 v[52:53], v5 offset:36928
    ds_read_b64_tr_b16 v[54:55], v5 offset:41536
    ds_read_b64_tr_b16 v[56:57], v5 offset:96
    ds_read_b64_tr_b16 v[58:59], v5 offset:4704
    ds_read_b64_tr_b16 v[60:61], v5 offset:36960
    ds_read_b64_tr_b16 v[62:63], v5 offset:41568
    s_waitcnt lgkmcnt(0)
    s_barrier
    ds_read_b128 v[64:67], v27
    ds_read_b128 v[68:71], v27 offset:64
    s_waitcnt lgkmcnt(0)
    v_mfma_f32_16x16x32_bf16 v[8:11], v[64:67], v[32:35], 0
    v_mfma_f32_16x16x32_bf16 v[12:15], v[64:67], v[40:43], 0
    v_mfma_f32_16x16x32_bf16 v[16:19], v[64:67], v[48:51], 0
    v_mfma_f32_16x16x32_bf16 v[20:23], v[64:67], v[56:59], 0
    v_mfma_f32_16x16x32_bf16 v[8:11], v[68:71], v[36:39], v[8:11]
    v_mfma_f32_16x16x32_bf16 v[12:15], v[68:71], v[44:47], v[12:15]
    v_mfma_f32_16x16x32_bf16 v[16:19], v[68:71], v[52:55], v[16:19]
    v_mfma_f32_16x16x32_bf16 v[20:23], v[68:71], v[60:63], v[20:23]
    s_nop 4
    v_mov_b32 v24, v8
    v_mov_b32_dpp v24, v12 quad_perm:[0,1,2,3] row_mask:0x2 bank_mask:0xf
    v_mov_b32_dpp v24, v16 quad_perm:[0,1,2,3] row_mask:0x4 bank_mask:0xf
    v_mov_b32_dpp v24, v20 quad_perm:[0,1,2,3] row_mask:0x8 bank_mask:0xf
    v_mov_b32 v25, v9
    v_mov_b32_dpp v25, v13 quad_perm:[0,1,2,3] row_mask:0x2 bank_mask:0xf
    v_mov_b32_dpp v25, v17 quad_perm:[0,1,2,3] row_mask:0x4 bank_mask:0xf
    v_mov_b32_dpp v25, v21 quad_perm:[0,1,2,3] row_mask:0x8 bank_mask:0xf
    v_add_u32 v24, 4, v24
    v_bfi_b32 v24, 7, s89, v24
    v_add_u32 v25, 4, v25
    v_bfi_b32 v25, 7, s89, v25
    buffer_store_dword v24, v26, s[12:15], 0 offen sc1
    buffer_store_dword v25, v26, s[12:15], 0 offen offset:2304 sc1
    s_endpgm
L_F:
    s_lshr_b32 s98, s95, 1
    s_mul_i32 s3, s98, 6144
    s_and_b32 s70, s95, 1
    s_lshl_b32 s70, s70, 5
    s_add_u32 s3, s3, s70
    s_add_u32 s3, s3, 47104
    v_lshrrev_b32 v4, 4, v1
    v_bfe_u32 v5, v1, 2, 2
    v_lshl_add_u32 v5, v4, 3, v5
    v_mul_u32_u24 v5, 64, v5
    v_and_b32 v4, 3, v1
    v_lshl_add_u32 v5, v4, 3, v5
    v_add_u32 v5, s3, v5
    s_mov_b32 s69, 0x200000
L_sp_18:
    ds_read_b32 v3, v0 offset:24
    s_waitcnt lgkmcnt(0)
    v_readfirstlane_b32 s70, v3
    s_cmp_eq_u32 s70, 12
    s_cbranch_scc1 L_sd_19
    s_sub_u32 s69, s69, 1
    s_cbranch_scc0 L_sp_18
L_sd_19:
    ds_read_b64_tr_b16 v[64:65], v5 offset:0
    ds_read_b64_tr_b16 v[66:67], v5 offset:256
    ds_read_b64_tr_b16 v[76:77], v5 offset:36864
    ds_read_b64_tr_b16 v[78:79], v5 offset:37120
    ds_read_b64_tr_b16 v[68:69], v5 offset:2048
    ds_read_b64_tr_b16 v[70:71], v5 offset:2304
    ds_read_b64_tr_b16 v[80:81], v5 offset:38912
    ds_read_b64_tr_b16 v[82:83], v5 offset:39168
    ds_read_b64_tr_b16 v[72:73], v5 offset:4096
    ds_read_b64_tr_b16 v[74:75], v5 offset:4352
    ds_read_b64_tr_b16 v[84:85], v5 offset:40960
    ds_read_b64_tr_b16 v[86:87], v5 offset:41216
    s_mul_i32 s3, s98, 192
    s_add_u32 s3, s3, 2816
    v_and_b32 v27, 1, v1
    v_mul_u32_u24 v27, 1152, v27
    v_lshrrev_b32 v4, 4, v1
    v_lshl_add_u32 v27, v4, 4, v27
    v_add_u32 v27, s3, v27
    s_lshl_b32 s3, s95, 8
    v_lshl_add_u32 v28, v1, 2, s3
    s_cmp_lt_u32 s95, 9
    s_cbranch_scc0 L_F2
    s_lshl_b32 s3, s95, 7
    s_add_u32 s3, s3, 120832
    v_lshrrev_b32 v4, 4, v1
    v_bfe_u32 v29, v1, 2, 2
    v_lshl_add_u32 v29, v4, 3, v29
    v_mul_u32_u24 v29, 1152, v29
    v_and_b32 v4, 3, v1
    v_lshl_add_u32 v29, v4, 3, v29
    v_add_u32 v29, s3, v29
    s_mul_i32 s70, s68, 4608
    s_lshl_b32 s3, s60, 8
    s_add_u32 s70, s70, s3
    s_add_u32 s70, s70, 589312
    v_lshl_add_u32 v26, v1, 2, s70
L_F2:
    s_waitcnt lgkmcnt(0)
    s_barrier
    ds_read_b128 v[48:51], v27 offset:0
    ds_read_b128 v[52:55], v27 offset:64
    ds_read_b128 v[56:59], v27 offset:128
    s_waitcnt lgkmcnt(0)
    v_mfma_f32_16x16x32_bf16 v[8:11], v[48:51], v[64:67], 0
    v_mfma_f32_16x16x32_bf16 v[12:15], v[48:51], v[76:79], 0
    v_mfma_f32_16x16x32_bf16 v[8:11], v[52:55], v[68:71], v[8:11]
    v_mfma_f32_16x16x32_bf16 v[12:15], v[52:55], v[80:83], v[12:15]
    v_mfma_f32_16x16x32_bf16 v[8:11], v[56:59], v[72:75], v[8:11]
    v_mfma_f32_16x16x32_bf16 v[12:15], v[56:59], v[84:87], v[12:15]
    v_lshrrev_b32 v5, 5, v1
    v_bfe_u32 v6, v1, 4, 1
    v_and_b32 v7, 15, v1
    v_lshlrev_b32 v7, 2, v7
    v_lshl_add_u32 v7, v5, 6, v7
    v_lshl_add_u32 v7, v6, 8, v7
    v_add_u32 v7, 5376, v7
    s_lshl_b32 s3, s95, 7
    s_add_u32 s3, s3, 8448
    v_lshl_add_u32 v6, v1, 1, s3
    v_and_b32 v5, 1, v1
    v_mul_u32_u24 v5, 64, v5
    v_lshrrev_b32 v4, 4, v1
    v_lshl_add_u32 v5, v4, 4, v5
    v_add_u32 v5, s3, v5
    v_mov_b32 v16, v8
    v_mov_b32_dpp v16, v9 quad_perm:[0,1,2,3] row_mask:0x2 bank_mask:0xf
    v_mov_b32_dpp v16, v12 quad_perm:[0,1,2,3] row_mask:0x4 bank_mask:0xf
    v_mov_b32_dpp v16, v13 quad_perm:[0,1,2,3] row_mask:0x8 bank_mask:0xf
    ds_write_b32 v28, v16 offset:5376
    s_waitcnt vmcnt(0) lgkmcnt(0)
    s_barrier
    s_cmp_lt_u32 s95, 9
    s_cbranch_scc0 L_end
    ds_read2st64_b32 v[8:9], v7 offset0:0 offset1:2
    ds_read2st64_b32 v[10:11], v7 offset0:4 offset1:6
    ds_read2st64_b32 v[12:13], v7 offset0:8 offset1:10
    v_add_u32 v7, 128, v7
    ds_read2st64_b32 v[14:15], v7 offset0:0 offset1:2
    ds_read2st64_b32 v[16:17], v7 offset0:4 offset1:6
    ds_read2st64_b32 v[18:19], v7 offset0:8 offset1:10
    ds_read_b64_tr_b16 v[32:33], v29 offset:0
    ds_read_b64_tr_b16 v[34:35], v29 offset:4608
    ds_read_b64_tr_b16 v[36:37], v29 offset:32
    ds_read_b64_tr_b16 v[38:39], v29 offset:4640
    ds_read_b64_tr_b16 v[40:41], v29 offset:64
    ds_read_b64_tr_b16 v[42:43], v29 offset:4672
    ds_read_b64_tr_b16 v[44:45], v29 offset:96
    ds_read_b64_tr_b16 v[46:47], v29 offset:4704
    s_waitcnt lgkmcnt(11)
    v_pk_add_f32 v[8:9], v[8:9], v[10:11]
    v_pk_add_f32 v[8:9], v[8:9], v[12:13]
    v_add_f32 v8, v8, v9
    s_waitcnt lgkmcnt(8)
    v_pk_add_f32 v[14:15], v[14:15], v[16:17]
    v_pk_add_f32 v[14:15], v[14:15], v[18:19]
    v_add_f32 v9, v14, v15
    v_cvt_pk_bf16_f32 v4, v8, v9
    v_lshlrev_b32 v8, 16, v4
    v_and_b32 v9, 0xffff0000, v4
    v_mul_f32 v10, v8, v8
    v_mul_f32 v10, v10, v8
    v_mov_b32 v11, v8
    v_fmac_f32 v11, 0x3d372713, v10
    v_mul_f32 v11, 0x40135761, v11
    v_exp_f32 v11, v11
    s_nop 0
    v_add_f32 v11, 1.0, v11
    v_rcp_f32 v11, v11
    v_mul_f32 v10, 0.5, v8
    v_fma_f32 v11, v11, -2.0, 2.0
    v_mul_f32 v10, v10, v11
    v_cvt_pk_bf16_f32 v10, v10, v10
    v_and_b32 v10, 0xffff0000, v10
    v_mul_f32 v10, v10, v9
    v_cvt_pk_bf16_f32 v10, v10, v10
    ds_write_b16 v6, v10
    s_waitcnt lgkmcnt(0)
    ds_read_b128 v[48:51], v5
    s_waitcnt lgkmcnt(0)
    v_mfma_f32_16x16x32_bf16 v[8:11], v[48:51], v[32:35], 0
    v_mfma_f32_16x16x32_bf16 v[12:15], v[48:51], v[36:39], 0
    v_mfma_f32_16x16x32_bf16 v[16:19], v[48:51], v[40:43], 0
    v_mfma_f32_16x16x32_bf16 v[20:23], v[48:51], v[44:47], 0
    s_nop 4
    v_mov_b32 v24, v8
    v_mov_b32_dpp v24, v12 quad_perm:[0,1,2,3] row_mask:0x2 bank_mask:0xf
    v_mov_b32_dpp v24, v16 quad_perm:[0,1,2,3] row_mask:0x4 bank_mask:0xf
    v_mov_b32_dpp v24, v20 quad_perm:[0,1,2,3] row_mask:0x8 bank_mask:0xf
    v_mov_b32 v25, v9
    v_mov_b32_dpp v25, v13 quad_perm:[0,1,2,3] row_mask:0x2 bank_mask:0xf
    v_mov_b32_dpp v25, v17 quad_perm:[0,1,2,3] row_mask:0x4 bank_mask:0xf
    v_mov_b32_dpp v25, v21 quad_perm:[0,1,2,3] row_mask:0x8 bank_mask:0xf
    v_add_u32 v24, 4, v24
    v_bfi_b32 v24, 7, s89, v24
    v_add_u32 v25, 4, v25
    v_bfi_b32 v25, 7, s89, v25
    buffer_store_dword v24, v26, s[12:15], 0 offen sc1
    buffer_store_dword v25, v26, s[12:15], 0 offen offset:2304 sc1
    s_endpgm
L_LN:
    s_sub_u32 s95, s60, 14
    s_mul_i32 s3, s95, 2304
    v_lshl_add_u32 v5, v1, 4, s3
    v_lshl_add_u32 v6, v1, 2, s3
    s_mul_i32 s3, s95, 1152
    v_lshl_add_u32 v29, v1, 3, s3
    v_lshl_add_u32 v31, v1, 1, s3
    s_mov_b32 s74, 13824
    s_mov_b32 s75, 18432
    s_mov_b32 s76, 106496
    s_mov_b32 s77, 41472
    s_mov_b32 s78, 46080
    s_mov_b32 s69, 0x8000
L_pl_20:
    buffer_load_dwordx4 v[88:91], v5, s[12:15], s74 offen sc1
    buffer_load_dwordx4 v[92:95], v5, s[12:15], s74 offen offset:1024 sc1
    buffer_load_dword v96, v6, s[12:15], s74 offen offset:2048 sc1
    buffer_load_dwordx4 v[98:101], v5, s[12:15], s75 offen sc1
    buffer_load_dwordx4 v[102:105], v5, s[12:15], s75 offen offset:1024 sc1
    buffer_load_dword v106, v6, s[12:15], s75 offen offset:2048 sc1
    buffer_load_dwordx4 v[32:35], v5, s[12:15], s77 offen sc1
    buffer_load_dwordx4 v[36:39], v5, s[12:15], s77 offen offset:1024 sc1
    buffer_load_dword v40, v6, s[12:15], s77 offen offset:2048 sc1
    buffer_load_dwordx4 v[42:45], v5, s[12:15], s78 offen sc1
    buffer_load_dwordx4 v[46:49], v5, s[12:15], s78 offen offset:1024 sc1
    buffer_load_dword v50, v6, s[12:15], s78 offen offset:2048 sc1
    s_waitcnt vmcnt(0)
    v_xor_b32 v88, s89, v88
    v_xor_b32 v89, s89, v89
    v_xor_b32 v90, s89, v90
    v_xor_b32 v91, s89, v91
    v_xor_b32 v92, s89, v92
    v_xor_b32 v93, s89, v93
    v_xor_b32 v94, s89, v94
    v_xor_b32 v95, s89, v95
    v_xor_b32 v96, s89, v96
    v_xor_b32 v98, s89, v98
    v_xor_b32 v99, s89, v99
    v_xor_b32 v100, s89, v100
    v_xor_b32 v101, s89, v101
    v_xor_b32 v102, s89, v102
    v_xor_b32 v103, s89, v103
    v_xor_b32 v104, s89, v104
    v_xor_b32 v105, s89, v105
    v_xor_b32 v106, s89, v106
    v_xor_b32 v32, s89, v32
    v_xor_b32 v33, s89, v33
    v_xor_b32 v34, s89, v34
    v_xor_b32 v35, s89, v35
    v_xor_b32 v36, s89, v36
    v_xor_b32 v37, s89, v37
    v_xor_b32 v38, s89, v38
    v_xor_b32 v39, s89, v39
    v_xor_b32 v40, s89, v40
    v_xor_b32 v42, s89, v42
    v_xor_b32 v43, s89, v43
    v_xor_b32 v44, s89, v44
    v_xor_b32 v45, s89, v45
    v_xor_b32 v46, s89, v46
    v_xor_b32 v47, s89, v47
    v_xor_b32 v48, s89, v48
    v_xor_b32 v49, s89, v49
    v_xor_b32 v50, s89, v50
    v_or_b32 v4, v88, v89
    v_or3_b32 v4, v4, v90, v91
    v_or3_b32 v4, v4, v92, v93
    v_or3_b32 v4, v4, v94, v95
    v_or3_b32 v4, v4, v96, v98
    v_or3_b32 v4, v4, v99, v100
    v_or3_b32 v4, v4, v101, v102
    v_or3_b32 v4, v4, v103, v104
    v_or3_b32 v4, v4, v105, v106
    v_or3_b32 v4, v4, v32, v33
    v_or3_b32 v4, v4, v34, v35
    v_or3_b32 v4, v4, v36, v37
    v_or3_b32 v4, v4, v38, v39
    v_or3_b32 v4, v4, v40, v42
    v_or3_b32 v4, v4, v43, v44
    v_or3_b32 v4, v4, v45, v46
    v_or3_b32 v4, v4, v47, v48
    v_or3_b32 v4, v4, v49, v50
    v_and_b32 v4, 7, v4
    v_cmp_ne_u16 vcc, 0, v4
    s_cbranch_vccz L_pd_21
    s_sub_u32 s69, s69, 1
    s_cbranch_scc0 L_pl_20
L_pd_21:
    v_add_f32 v88, v88, v32
    v_add_f32 v98, v98, v42
    v_add_f32 v89, v89, v33
    v_add_f32 v99, v99, v43
    v_add_f32 v90, v90, v34
    v_add_f32 v100, v100, v44
    v_add_f32 v91, v91, v35
    v_add_f32 v101, v101, v45
    v_add_f32 v92, v92, v36
    v_add_f32 v102, v102, v46
    v_add_f32 v93, v93, v37
    v_add_f32 v103, v103, v47
    v_add_f32 v94, v94, v38
    v_add_f32 v104, v104, v48
    v_add_f32 v95, v95, v39
    v_add_f32 v105, v105, v49
    v_add_f32 v96, v96, v40
    v_add_f32 v106, v106, v50
    v_cvt_pk_bf16_f32 v4, v88, v89
    v_lshlrev_b32 v88, 16, v4
    v_and_b32 v89, 0xffff0000, v4
    v_cvt_pk_bf16_f32 v4, v98, v99
    v_lshlrev_b32 v98, 16, v4
    v_and_b32 v99, 0xffff0000, v4
    v_cvt_pk_bf16_f32 v4, v90, v91
    v_lshlrev_b32 v90, 16, v4
    v_and_b32 v91, 0xffff0000, v4
    v_cvt_pk_bf16_f32 v4, v100, v101
    v_lshlrev_b32 v100, 16, v4
    v_and_b32 v101, 0xffff0000, v4
    v_cvt_pk_bf16_f32 v4, v92, v93
    v_lshlrev_b32 v92, 16, v4
    v_and_b32 v93, 0xffff0000, v4
    v_cvt_pk_bf16_f32 v4, v102, v103
    v_lshlrev_b32 v102, 16, v4
    v_and_b32 v103, 0xffff0000, v4
    v_cvt_pk_bf16_f32 v4, v94, v95
    v_lshlrev_b32 v94, 16, v4
    v_and_b32 v95, 0xffff0000, v4
    v_cvt_pk_bf16_f32 v4, v104, v105
    v_lshlrev_b32 v104, 16, v4
    v_and_b32 v105, 0xffff0000, v4
    v_cvt_pk_bf16_f32 v4, v96, v97
    v_lshlrev_b32 v96, 16, v4
    v_and_b32 v97, 0xffff0000, v4
    v_cvt_pk_bf16_f32 v4, v106, v107
    v_lshlrev_b32 v106, 16, v4
    v_and_b32 v107, 0xffff0000, v4
    v_add_f32 v98, 1.0, v98
    v_add_f32 v99, 1.0, v99
    v_add_f32 v100, 1.0, v100
    v_add_f32 v101, 1.0, v101
    v_add_f32 v102, 1.0, v102
    v_add_f32 v103, 1.0, v103
    v_add_f32 v104, 1.0, v104
    v_add_f32 v105, 1.0, v105
    v_add_f32 v106, 1.0, v106
    v_cvt_pk_bf16_f32 v4, v98, v99
    v_lshlrev_b32 v98, 16, v4
    v_and_b32 v99, 0xffff0000, v4
    v_cvt_pk_bf16_f32 v4, v100, v101
    v_lshlrev_b32 v100, 16, v4
    v_and_b32 v101, 0xffff0000, v4
    v_cvt_pk_bf16_f32 v4, v102, v103
    v_lshlrev_b32 v102, 16, v4
    v_and_b32 v103, 0xffff0000, v4
    v_cvt_pk_bf16_f32 v4, v104, v105
    v_lshlrev_b32 v104, 16, v4
    v_and_b32 v105, 0xffff0000, v4
    v_cvt_pk_bf16_f32 v4, v106, v107
    v_lshlrev_b32 v106, 16, v4
    v_and_b32 v107, 0xffff0000, v4
    v_mov_b32 v17, 0
    v_mov_b32 v97, 0
    s_mov_b32 s69, 0x8000
L_pl_22:
    buffer_load_dwordx4 v[32:35], v5, s[12:15], s76 offen sc1
    buffer_load_dwordx4 v[36:39], v5, s[12:15], s76 offen offset:1024 sc1
    buffer_load_dword v40, v6, s[12:15], s76 offen offset:2048 sc1
    s_waitcnt vmcnt(0)
    v_xor_b32 v32, s89, v32
    v_xor_b32 v33, s89, v33
    v_xor_b32 v34, s89, v34
    v_xor_b32 v35, s89, v35
    v_xor_b32 v36, s89, v36
    v_xor_b32 v37, s89, v37
    v_xor_b32 v38, s89, v38
    v_xor_b32 v39, s89, v39
    v_xor_b32 v40, s89, v40
    v_or3_b32 v4, v32, v33, v34
    v_or3_b32 v4, v4, v35, v36
    v_or3_b32 v4, v4, v37, v38
    v_or3_b32 v4, v4, v39, v40
    v_cmp_ne_u16 vcc, 0, v4
    s_cbranch_vccz L_pd_23
    s_sub_u32 s69, s69, 1
    s_cbranch_scc0 L_pl_22
L_pd_23:
    v_mov_b32 v8, v32
    v_mov_b32 v9, v33
    v_mov_b32 v10, v34
    v_mov_b32 v11, v35
    v_mov_b32 v12, v36
    v_mov_b32 v13, v37
    v_mov_b32 v14, v38
    v_mov_b32 v15, v39
    v_mov_b32 v16, v40
    v_pk_add_f32 v[18:19], v[8:9], v[10:11]
    v_pk_add_f32 v[20:21], v[12:13], v[14:15]
    v_pk_add_f32 v[18:19], v[18:19], v[16:17]
    v_pk_add_f32 v[18:19], v[18:19], v[20:21]
    v_add_f32 v18, v18, v19
    s_nop 1
    v_add_f32_dpp v18, v18, v18 row_ror:8 row_mask:0xf bank_mask:0xf
    s_nop 1
    v_add_f32_dpp v18, v18, v18 row_ror:4 row_mask:0xf bank_mask:0xf
    s_nop 1
    v_add_f32_dpp v18, v18, v18 row_ror:2 row_mask:0xf bank_mask:0xf
    s_nop 1
    v_add_f32_dpp v18, v18, v18 row_ror:1 row_mask:0xf bank_mask:0xf
    v_mov_b32 v4, v18
    s_nop 1
    v_permlane16_swap_b32 v18, v4
    v_add_f32 v18, v18, v4
    v_mov_b32 v4, v18
    s_nop 1
    v_permlane32_swap_b32 v18, v4
    v_add_f32 v18, v18, v4
    v_mul_f32 v18, 0xbae38e39, v18
    v_pk_add_f32 v[108:109], v[8:9], v[18:19] op_sel_hi:[1,0]
    v_pk_add_f32 v[110:111], v[10:11], v[18:19] op_sel_hi:[1,0]
    v_pk_add_f32 v[112:113], v[12:13], v[18:19] op_sel_hi:[1,0]
    v_pk_add_f32 v[114:115], v[14:15], v[18:19] op_sel_hi:[1,0]
    v_pk_add_f32 v[116:117], v[16:17], v[18:19] op_sel_hi:[1,0]
    v_pk_mul_f32 v[20:21], v[108:109], v[108:109]
    v_pk_fma_f32 v[20:21], v[110:111], v[110:111], v[20:21]
    v_pk_fma_f32 v[20:21], v[112:113], v[112:113], v[20:21]
    v_pk_fma_f32 v[20:21], v[114:115], v[114:115], v[20:21]
    v_fmac_f32 v20, v116, v116
    v_cvt_pk_bf16_f32 v18, v18, v18
    v_and_b32 v18, 0xffff0000, v18
    v_add_f32 v19, v20, v21
    s_nop 1
    v_add_f32_dpp v19, v19, v19 row_ror:8 row_mask:0xf bank_mask:0xf
    s_nop 1
    v_add_f32_dpp v19, v19, v19 row_ror:4 row_mask:0xf bank_mask:0xf
    s_nop 1
    v_add_f32_dpp v19, v19, v19 row_ror:2 row_mask:0xf bank_mask:0xf
    s_nop 1
    v_add_f32_dpp v19, v19, v19 row_ror:1 row_mask:0xf bank_mask:0xf
    v_mov_b32 v4, v19
    s_nop 1
    v_permlane16_swap_b32 v19, v4
    v_add_f32 v19, v19, v4
    v_mov_b32 v4, v19
    s_nop 1
    v_permlane32_swap_b32 v19, v4
    v_add_f32 v19, v19, v4
    v_pk_add_f32 v[8:9], v[8:9], v[18:19] op_sel_hi:[1,0]
    v_pk_add_f32 v[10:11], v[10:11], v[18:19] op_sel_hi:[1,0]
    v_pk_add_f32 v[12:13], v[12:13], v[18:19] op_sel_hi:[1,0]
    v_pk_add_f32 v[14:15], v[14:15], v[18:19] op_sel_hi:[1,0]
    v_pk_add_f32 v[16:17], v[16:17], v[18:19] op_sel_hi:[1,0]
    v_mul_f32 v19, 0x3ae38e39, v19
    v_cvt_pk_bf16_f32 v19, v19, v19
    v_and_b32 v19, 0xffff0000, v19
    v_add_f32 v19, 0x3727c5ac, v19
    v_cvt_pk_bf16_f32 v19, v19, v19
    v_and_b32 v19, 0xffff0000, v19
    v_sqrt_f32 v19, v19
    s_nop 0
    v_cvt_pk_bf16_f32 v19, v19, v19
    v_and_b32 v19, 0xffff0000, v19
    v_rcp_f32 v20, v19
    v_cvt_pk_bf16_f32 v22, v8, v9
    v_lshlrev_b32 v8, 16, v22
    v_and_b32 v9, 0xffff0000, v22
    v_cvt_pk_bf16_f32 v23, v10, v11
    v_lshlrev_b32 v10, 16, v23
    v_and_b32 v11, 0xffff0000, v23
    v_cvt_pk_bf16_f32 v24, v12, v13
    v_lshlrev_b32 v12, 16, v24
    v_and_b32 v13, 0xffff0000, v24
    v_cvt_pk_bf16_f32 v25, v14, v15
    v_lshlrev_b32 v14, 16, v25
    v_and_b32 v15, 0xffff0000, v25
    v_cvt_pk_bf16_f32 v26, v16, v17
    v_lshlrev_b32 v16, 16, v26
    v_and_b32 v17, 0xffff0000, v26
    v_pk_mul_f32 v[8:9], v[8:9], v[20:21] op_sel_hi:[1,0]
    v_pk_mul_f32 v[10:11], v[10:11], v[20:21] op_sel_hi:[1,0]
    v_pk_mul_f32 v[12:13], v[12:13], v[20:21] op_sel_hi:[1,0]
    v_pk_mul_f32 v[14:15], v[14:15], v[20:21] op_sel_hi:[1,0]
    v_pk_mul_f32 v[16:17], v[16:17], v[20:21] op_sel_hi:[1,0]
    v_cvt_pk_bf16_f32 v22, v8, v9
    v_lshlrev_b32 v8, 16, v22
    v_and_b32 v9, 0xffff0000, v22
    v_cvt_pk_bf16_f32 v23, v10, v11
    v_lshlrev_b32 v10, 16, v23
    v_and_b32 v11, 0xffff0000, v23
    v_cvt_pk_bf16_f32 v24, v12, v13
    v_lshlrev_b32 v12, 16, v24
    v_and_b32 v13, 0xffff0000, v24
    v_cvt_pk_bf16_f32 v25, v14, v15
    v_lshlrev_b32 v14, 16, v25
    v_and_b32 v15, 0xffff0000, v25
    v_cvt_pk_bf16_f32 v26, v16, v17
    v_lshlrev_b32 v16, 16, v26
    v_and_b32 v17, 0xffff0000, v26
    v_pk_mul_f32 v[8:9], v[8:9], v[98:99]
    v_pk_mul_f32 v[10:11], v[10:11], v[100:101]
    v_pk_mul_f32 v[12:13], v[12:13], v[102:103]
    v_pk_mul_f32 v[14:15], v[14:15], v[104:105]
    v_pk_mul_f32 v[16:17], v[16:17], v[106:107]
    v_cvt_pk_bf16_f32 v22, v8, v9
    v_lshlrev_b32 v8, 16, v22
    v_and_b32 v9, 0xffff0000, v22
    v_cvt_pk_bf16_f32 v23, v10, v11
    v_lshlrev_b32 v10, 16, v23
    v_and_b32 v11, 0xffff0000, v23
    v_cvt_pk_bf16_f32 v24, v12, v13
    v_lshlrev_b32 v12, 16, v24
    v_and_b32 v13, 0xffff0000, v24
    v_cvt_pk_bf16_f32 v25, v14, v15
    v_lshlrev_b32 v14, 16, v25
    v_and_b32 v15, 0xffff0000, v25
    v_cvt_pk_bf16_f32 v26, v16, v17
    v_lshlrev_b32 v16, 16, v26
    v_and_b32 v17, 0xffff0000, v26
    v_pk_add_f32 v[8:9], v[8:9], v[88:89]
    v_pk_add_f32 v[10:11], v[10:11], v[90:91]
    v_pk_add_f32 v[12:13], v[12:13], v[92:93]
    v_pk_add_f32 v[14:15], v[14:15], v[94:95]
    v_pk_add_f32 v[16:17], v[16:17], v[96:97]
    v_cvt_pk_bf16_f32 v108, v8, v9
    v_cvt_pk_bf16_f32 v109, v10, v11
    v_cvt_pk_bf16_f32 v110, v12, v13
    v_cvt_pk_bf16_f32 v111, v14, v15
    v_cvt_pk_bf16_f32 v112, v16, v17
    ds_write_b64 v29, v[108:109] offset:2816
    ds_write_b64 v29, v[110:111] offset:3328
    ds_write_b16 v31, v112 offset:3840
    s_waitcnt lgkmcnt(0)
    s_barrier
    s_endpgm
L_waveB:
    s_setprio 3
    s_mov_b32 s20, s32
    s_mov_b32 s21, s33
    s_mov_b32 s22, 2304
    s_mov_b32 s23, 0x20000
    v_lshrrev_b32 v53, 5, v1
    v_mul_u32_u24 v53, 1152, v53
    v_and_b32 v55, 31, v1
    v_mul_u32_u24 v55, 36, v55
    v_add_u32 v55, v55, v53
    buffer_load_dwordx4 v[26:29], v55, s[20:23], 0 offen offset:0
    buffer_load_dwordx4 v[30:33], v55, s[20:23], 0 offen offset:16
    buffer_load_dword v34, v55, s[20:23], 0 offen offset:32
    s_barrier
    s_lshl_b32 s99, s99, 1
    s_lshl_b32 s3, s65, 15
    s_add_u32 s99, s99, s3
    s_add_u32 s99, s99, 1253376
    s_waitcnt vmcnt(0)
    v_and_b32 v9, 0xffff0000, v26
    v_lshlrev_b32 v8, 16, v26
    v_and_b32 v11, 0xffff0000, v27
    v_lshlrev_b32 v10, 16, v27
    v_and_b32 v13, 0xffff0000, v28
    v_lshlrev_b32 v12, 16, v28
    v_and_b32 v15, 0xffff0000, v29
    v_lshlrev_b32 v14, 16, v29
    v_and_b32 v17, 0xffff0000, v30
    v_lshlrev_b32 v16, 16, v30
    v_and_b32 v19, 0xffff0000, v31
    v_lshlrev_b32 v18, 16, v31
    v_and_b32 v21, 0xffff0000, v32
    v_lshlrev_b32 v20, 16, v32
    v_and_b32 v23, 0xffff0000, v33
    v_lshlrev_b32 v22, 16, v33
    v_and_b32 v25, 0xffff0000, v34
    v_lshlrev_b32 v24, 16, v34
    v_add_f32 v26, v8, v9
    v_add_f32 v26, v26, v10
    v_add_f32 v26, v26, v11
    v_add_f32 v26, v26, v12
    v_add_f32 v26, v26, v13
    v_add_f32 v26, v26, v14
    v_add_f32 v26, v26, v15
    v_add_f32 v26, v26, v16
    v_add_f32 v26, v26, v17
    v_add_f32 v26, v26, v18
    v_add_f32 v26, v26, v19
    v_add_f32 v26, v26, v20
    v_add_f32 v26, v26, v21
    v_add_f32 v26, v26, v22
    v_add_f32 v26, v26, v23
    v_add_f32 v26, v26, v24
    v_add_f32 v26, v26, v25
    s_nop 1
    v_add_f32_dpp v26, v26, v26 row_ror:8 row_mask:0xf bank_mask:0xf
    s_nop 1
    v_add_f32_dpp v26, v26, v26 row_ror:4 row_mask:0xf bank_mask:0xf
    s_nop 1
    v_add_f32_dpp v26, v26, v26 row_ror:2 row_mask:0xf bank_mask:0xf
    s_nop 1
    v_add_f32_dpp v26, v26, v26 row_ror:1 row_mask:0xf bank_mask:0xf
    v_mov_b32 v4, v26
    s_nop 1
    v_permlane16_swap_b32 v26, v4
    v_add_f32 v26, v26, v4
    v_mul_f32 v26, 0x3ae38e39, v26
    v_mov_b32 v27, 0
    v_sub_f32 v4, v8, v26
    v_fmac_f32 v27, v4, v4
    v_sub_f32 v4, v9, v26
    v_fmac_f32 v27, v4, v4
    v_sub_f32 v4, v10, v26
    v_fmac_f32 v27, v4, v4
    v_sub_f32 v4, v11, v26
    v_fmac_f32 v27, v4, v4
    v_sub_f32 v4, v12, v26
    v_fmac_f32 v27, v4, v4
    v_sub_f32 v4, v13, v26
    v_fmac_f32 v27, v4, v4
    v_sub_f32 v4, v14, v26
    v_fmac_f32 v27, v4, v4
    v_sub_f32 v4, v15, v26
    v_fmac_f32 v27, v4, v4
    v_sub_f32 v4, v16, v26
    v_fmac_f32 v27, v4, v4
    v_sub_f32 v4, v17, v26
    v_fmac_f32 v27, v4, v4
    v_sub_f32 v4, v18, v26
    v_fmac_f32 v27, v4, v4
    v_sub_f32 v4, v19, v26
    v_fmac_f32 v27, v4, v4
    v_sub_f32 v4, v20, v26
    v_fmac_f32 v27, v4, v4
    v_sub_f32 v4, v21, v26
    v_fmac_f32 v27, v4, v4
    v_sub_f32 v4, v22, v26
    v_fmac_f32 v27, v4, v4
    v_sub_f32 v4, v23, v26
    v_fmac_f32 v27, v4, v4
    v_sub_f32 v4, v24, v26
    v_fmac_f32 v27, v4, v4
    v_sub_f32 v4, v25, v26
    v_fmac_f32 v27, v4, v4
    s_nop 1
    v_add_f32_dpp v27, v27, v27 row_ror:8 row_mask:0xf bank_mask:0xf
    s_nop 1
    v_add_f32_dpp v27, v27, v27 row_ror:4 row_mask:0xf bank_mask:0xf
    s_nop 1
    v_add_f32_dpp v27, v27, v27 row_ror:2 row_mask:0xf bank_mask:0xf
    s_nop 1
    v_add_f32_dpp v27, v27, v27 row_ror:1 row_mask:0xf bank_mask:0xf
    v_mov_b32 v4, v27
    s_nop 1
    v_permlane16_swap_b32 v27, v4
    v_add_f32 v27, v27, v4
    v_cvt_pk_bf16_f32 v26, v26, v26
    v_and_b32 v26, 0xffff0000, v26
    v_mul_f32 v27, 0x3ae38e39, v27
    v_cvt_pk_bf16_f32 v27, v27, v27
    v_and_b32 v27, 0xffff0000, v27
    v_add_f32 v27, 0x3727c5ac, v27
    v_cvt_pk_bf16_f32 v27, v27, v27
    v_and_b32 v27, 0xffff0000, v27
    v_sqrt_f32 v27, v27
    s_nop 0
    v_cvt_pk_bf16_f32 v27, v27, v27
    v_and_b32 v27, 0xffff0000, v27
    v_rcp_f32 v28, v27
    v_sub_f32 v8, v8, v26
    v_sub_f32 v9, v9, v26
    v_cvt_pk_bf16_f32 v4, v8, v9
    v_lshlrev_b32 v8, 16, v4
    v_and_b32 v9, 0xffff0000, v4
    v_mul_f32 v5, v8, v28
    v_mul_f32 v6, v9, v28
    v_fma_f32 v8, -v5, v27, v8
    v_fma_f32 v9, -v6, v27, v9
    v_fma_f32 v8, v8, v28, v5
    v_fma_f32 v9, v9, v28, v6
    v_cvt_pk_bf16_f32 v8, v8, v9
    v_sub_f32 v10, v10, v26
    v_sub_f32 v11, v11, v26
    v_cvt_pk_bf16_f32 v4, v10, v11
    v_lshlrev_b32 v10, 16, v4
    v_and_b32 v11, 0xffff0000, v4
    v_mul_f32 v5, v10, v28
    v_mul_f32 v6, v11, v28
    v_fma_f32 v10, -v5, v27, v10
    v_fma_f32 v11, -v6, v27, v11
    v_fma_f32 v10, v10, v28, v5
    v_fma_f32 v11, v11, v28, v6
    v_cvt_pk_bf16_f32 v9, v10, v11
    v_sub_f32 v12, v12, v26
    v_sub_f32 v13, v13, v26
    v_cvt_pk_bf16_f32 v4, v12, v13
    v_lshlrev_b32 v12, 16, v4
    v_and_b32 v13, 0xffff0000, v4
    v_mul_f32 v5, v12, v28
    v_mul_f32 v6, v13, v28
    v_fma_f32 v12, -v5, v27, v12
    v_fma_f32 v13, -v6, v27, v13
    v_fma_f32 v12, v12, v28, v5
    v_fma_f32 v13, v13, v28, v6
    v_cvt_pk_bf16_f32 v10, v12, v13
    v_sub_f32 v14, v14, v26
    v_sub_f32 v15, v15, v26
    v_cvt_pk_bf16_f32 v4, v14, v15
    v_lshlrev_b32 v14, 16, v4
    v_and_b32 v15, 0xffff0000, v4
    v_mul_f32 v5, v14, v28
    v_mul_f32 v6, v15, v28
    v_fma_f32 v14, -v5, v27, v14
    v_fma_f32 v15, -v6, v27, v15
    v_fma_f32 v14, v14, v28, v5
    v_fma_f32 v15, v15, v28, v6
    v_cvt_pk_bf16_f32 v11, v14, v15
    v_sub_f32 v16, v16, v26
    v_sub_f32 v17, v17, v26
    v_cvt_pk_bf16_f32 v4, v16, v17
    v_lshlrev_b32 v16, 16, v4
    v_and_b32 v17, 0xffff0000, v4
    v_mul_f32 v5, v16, v28
    v_mul_f32 v6, v17, v28
    v_fma_f32 v16, -v5, v27, v16
    v_fma_f32 v17, -v6, v27, v17
    v_fma_f32 v16, v16, v28, v5
    v_fma_f32 v17, v17, v28, v6
    v_cvt_pk_bf16_f32 v12, v16, v17
    v_sub_f32 v18, v18, v26
    v_sub_f32 v19, v19, v26
    v_cvt_pk_bf16_f32 v4, v18, v19
    v_lshlrev_b32 v18, 16, v4
    v_and_b32 v19, 0xffff0000, v4
    v_mul_f32 v5, v18, v28
    v_mul_f32 v6, v19, v28
    v_fma_f32 v18, -v5, v27, v18
    v_fma_f32 v19, -v6, v27, v19
    v_fma_f32 v18, v18, v28, v5
    v_fma_f32 v19, v19, v28, v6
    v_cvt_pk_bf16_f32 v13, v18, v19
    v_sub_f32 v20, v20, v26
    v_sub_f32 v21, v21, v26
    v_cvt_pk_bf16_f32 v4, v20, v21
    v_lshlrev_b32 v20, 16, v4
    v_and_b32 v21, 0xffff0000, v4
    v_mul_f32 v5, v20, v28
    v_mul_f32 v6, v21, v28
    v_fma_f32 v20, -v5, v27, v20
    v_fma_f32 v21, -v6, v27, v21
    v_fma_f32 v20, v20, v28, v5
    v_fma_f32 v21, v21, v28, v6
    v_cvt_pk_bf16_f32 v14, v20, v21
    v_sub_f32 v22, v22, v26
    v_sub_f32 v23, v23, v26
    v_cvt_pk_bf16_f32 v4, v22, v23
    v_lshlrev_b32 v22, 16, v4
    v_and_b32 v23, 0xffff0000, v4
    v_mul_f32 v5, v22, v28
    v_mul_f32 v6, v23, v28
    v_fma_f32 v22, -v5, v27, v22
    v_fma_f32 v23, -v6, v27, v23
    v_fma_f32 v22, v22, v28, v5
    v_fma_f32 v23, v23, v28, v6
    v_cvt_pk_bf16_f32 v15, v22, v23
    v_sub_f32 v24, v24, v26
    v_sub_f32 v25, v25, v26
    v_cvt_pk_bf16_f32 v4, v24, v25
    v_lshlrev_b32 v24, 16, v4
    v_and_b32 v25, 0xffff0000, v4
    v_mul_f32 v5, v24, v28
    v_mul_f32 v6, v25, v28
    v_fma_f32 v24, -v5, v27, v24
    v_fma_f32 v25, -v6, v27, v25
    v_fma_f32 v24, v24, v28, v5
    v_fma_f32 v25, v25, v28, v6
    v_cvt_pk_bf16_f32 v16, v24, v25
    ds_write_b32 v55, v8 offset:2816
    ds_write_b32 v55, v9 offset:2820
    ds_write_b32 v55, v10 offset:2824
    ds_write_b32 v55, v11 offset:2828
    ds_write_b32 v55, v12 offset:2832
    ds_write_b32 v55, v13 offset:2836
    ds_write_b32 v55, v14 offset:2840
    ds_write_b32 v55, v15 offset:2844
    ds_write_b32 v55, v16 offset:2848
    v_lshrrev_b32 v4, 5, v1
    v_mul_u32_u24 v4, 1152, v4
    s_mul_i32 s3, s65, 576
    v_add_u32 v4, s3, v4
    v_and_b32 v5, 31, v1
    v_lshl_add_u32 v55, v5, 3, v4
    v_lshl_add_u32 v7, v5, 1, v4
    v_lshlrev_b32 v16, 1, v55
    v_lshlrev_b32 v17, 1, v7
    s_mov_b32 s74, 4608
    ds_read_b64 v[8:9], v55 offset:2816
    ds_read_b64 v[10:11], v55 offset:3072
    ds_read_u16 v12, v7 offset:3328
    v_bfe_u32 v53, v1, 4, 1
    v_mul_u32_u24 v53, 16384, v53
    v_and_b32 v4, 15, v1
    v_lshl_add_u32 v53, v4, 2, v53
    v_lshrrev_b32 v4, 5, v1
    v_lshl_add_u32 v53, v4, 6, v53
    v_add_u32 v53, s99, v53
    s_lshl_b32 s3, s94, 9
    s_add_u32 s3, s3, 1253376
    v_lshl_add_u32 v52, v1, 3, s3
    s_mov_b32 s75, 32768
    s_mul_i32 s3, s65, 576
    s_add_u32 s3, s3, 2816
    v_and_b32 v51, 1, v1
    v_mul_u32_u24 v51, 1152, v51
    v_lshrrev_b32 v4, 4, v1
    v_lshl_add_u32 v51, v4, 4, v51
    v_add_u32 v51, s3, v51
    v_lshrrev_b32 v4, 4, v1
    v_bfe_u32 v50, v1, 2, 2
    v_lshl_add_u32 v50, v4, 3, v50
    v_mul_u32_u24 v50, 64, v50
    v_and_b32 v4, 3, v1
    v_lshl_add_u32 v50, v4, 3, v50
    v_add_u32 v50, 28672, v50
    s_mov_b32 s69, 0x200000
L_sp_24:
    ds_read_b32 v3, v0 offset:36
    s_waitcnt lgkmcnt(0)
    v_readfirstlane_b32 s70, v3
    s_cmp_eq_u32 s70, 6
    s_cbranch_scc1 L_sd_25
    s_sub_u32 s69, s69, 1
    s_cbranch_scc0 L_sp_24
L_sd_25:
    s_add_u32 s88, s88, 1
    s_and_b32 s89, s88, 7
    ds_read_b64_tr_b16 v[56:57], v50 offset:0
    ds_read_b64_tr_b16 v[58:59], v50 offset:256
    ds_read_b64_tr_b16 v[60:61], v50 offset:32
    ds_read_b64_tr_b16 v[62:63], v50 offset:288
    ds_read_b64_tr_b16 v[64:65], v50 offset:2048
    ds_read_b64_tr_b16 v[66:67], v50 offset:2304
    ds_read_b64_tr_b16 v[68:69], v50 offset:2080
    ds_read_b64_tr_b16 v[70:71], v50 offset:2336
    ds_read_b64_tr_b16 v[72:73], v50 offset:4096
    ds_read_b64_tr_b16 v[74:75], v50 offset:4352
    ds_read_b64_tr_b16 v[76:77], v50 offset:4128
    ds_read_b64_tr_b16 v[78:79], v50 offset:4384
    ds_read_b64_tr_b16 v[80:81], v50 offset:6144
    ds_read_b64_tr_b16 v[82:83], v50 offset:6400
    ds_read_b64_tr_b16 v[84:85], v50 offset:6176
    ds_read_b64_tr_b16 v[86:87], v50 offset:6432
    ds_read_b64_tr_b16 v[88:89], v50 offset:8192
    ds_read_b64_tr_b16 v[90:91], v50 offset:8448
    ds_read_b64_tr_b16 v[92:93], v50 offset:8224
    ds_read_b64_tr_b16 v[94:95], v50 offset:8480
    ds_read_b64_tr_b16 v[96:97], v50 offset:10240
    ds_read_b64_tr_b16 v[98:99], v50 offset:10496
    ds_read_b64_tr_b16 v[100:101], v50 offset:10272
    ds_read_b64_tr_b16 v[102:103], v50 offset:10528
    ds_read_b64_tr_b16 v[104:105], v50 offset:12288
    ds_read_b64_tr_b16 v[106:107], v50 offset:12544
    ds_read_b64_tr_b16 v[108:109], v50 offset:12320
    ds_read_b64_tr_b16 v[110:111], v50 offset:12576
    ds_read_b64_tr_b16 v[112:113], v50 offset:14336
    ds_read_b64_tr_b16 v[114:115], v50 offset:14592
    ds_read_b64_tr_b16 v[116:117], v50 offset:14368
    ds_read_b64_tr_b16 v[118:119], v50 offset:14624
    ds_read_b64_tr_b16 v[120:121], v50 offset:16384
    ds_read_b64_tr_b16 v[122:123], v50 offset:16640
    ds_read_b64_tr_b16 v[124:125], v50 offset:16416
    ds_read_b64_tr_b16 v[126:127], v50 offset:16672
    s_mov_b32 s69, 0x200000
L_sp_26:
    ds_read_b32 v3, v0 offset:44
    s_waitcnt lgkmcnt(0)
    v_readfirstlane_b32 s70, v3
    s_cmp_eq_u32 s70, 1
    s_cbranch_scc1 L_sd_27
    s_sub_u32 s69, s69, 1
    s_cbranch_scc0 L_sp_26
L_sd_27:
    s_mov_b32 s76, 27648
    s_mov_b32 s77, 32256
    s_mov_b32 s69, 0x8000
L_pl_28:
    buffer_load_dwordx4 v[18:21], v16, s[12:15], s74 offen sc1
    buffer_load_dwordx4 v[22:25], v16, s[12:15], s74 offen offset:512 sc1
    buffer_load_dword v13, v17, s[12:15], s74 offen offset:1024 sc1
    buffer_load_dwordx4 v[26:29], v16, s[12:15], 0 offen sc1
    buffer_load_dwordx4 v[30:33], v16, s[12:15], 0 offen offset:512 sc1
    buffer_load_dword v14, v17, s[12:15], 0 offen offset:1024 sc1
    buffer_load_dwordx4 v[34:37], v16, s[12:15], s77 offen sc1
    buffer_load_dwordx4 v[38:41], v16, s[12:15], s77 offen offset:512 sc1
    buffer_load_dword v15, v17, s[12:15], s77 offen offset:1024 sc1
    buffer_load_dwordx4 v[42:45], v16, s[12:15], s76 offen sc1
    buffer_load_dwordx4 v[46:49], v16, s[12:15], s76 offen offset:512 sc1
    buffer_load_dword v3, v17, s[12:15], s76 offen offset:1024 sc1
    s_waitcnt vmcnt(0)
    v_xor_b32 v18, s89, v18
    v_xor_b32 v19, s89, v19
    v_xor_b32 v20, s89, v20
    v_xor_b32 v21, s89, v21
    v_xor_b32 v22, s89, v22
    v_xor_b32 v23, s89, v23
    v_xor_b32 v24, s89, v24
    v_xor_b32 v25, s89, v25
    v_xor_b32 v26, s89, v26
    v_xor_b32 v27, s89, v27
    v_xor_b32 v28, s89, v28
    v_xor_b32 v29, s89, v29
    v_xor_b32 v30, s89, v30
    v_xor_b32 v31, s89, v31
    v_xor_b32 v32, s89, v32
    v_xor_b32 v33, s89, v33
    v_xor_b32 v34, s89, v34
    v_xor_b32 v35, s89, v35
    v_xor_b32 v36, s89, v36
    v_xor_b32 v37, s89, v37
    v_xor_b32 v38, s89, v38
    v_xor_b32 v39, s89, v39
    v_xor_b32 v40, s89, v40
    v_xor_b32 v41, s89, v41
    v_xor_b32 v42, s89, v42
    v_xor_b32 v43, s89, v43
    v_xor_b32 v44, s89, v44
    v_xor_b32 v45, s89, v45
    v_xor_b32 v46, s89, v46
    v_xor_b32 v47, s89, v47
    v_xor_b32 v48, s89, v48
    v_xor_b32 v49, s89, v49
    v_xor_b32 v13, s89, v13
    v_xor_b32 v14, s89, v14
    v_xor_b32 v15, s89, v15
    v_xor_b32 v3, s89, v3
    v_or_b32 v4, v18, v19
    v_or3_b32 v4, v4, v20, v21
    v_or3_b32 v4, v4, v22, v23
    v_or3_b32 v4, v4, v24, v25
    v_or3_b32 v4, v4, v26, v27
    v_or3_b32 v4, v4, v28, v29
    v_or3_b32 v4, v4, v30, v31
    v_or3_b32 v4, v4, v32, v33
    v_or3_b32 v4, v4, v34, v35
    v_or3_b32 v4, v4, v36, v37
    v_or3_b32 v4, v4, v38, v39
    v_or3_b32 v4, v4, v40, v41
    v_or3_b32 v4, v4, v42, v43
    v_or3_b32 v4, v4, v44, v45
    v_or3_b32 v4, v4, v46, v47
    v_or3_b32 v4, v4, v48, v49
    v_or3_b32 v4, v4, v13, v14
    v_or3_b32 v4, v4, v15, v3
    v_and_b32 v4, 7, v4
    v_cmp_ne_u16 vcc, 0, v4
    s_cbranch_vccz L_pd_29
    s_sub_u32 s69, s69, 1
    s_cbranch_scc0 L_pl_28
L_pd_29:
    v_pk_add_f32 v[18:19], v[18:19], v[34:35]
    v_pk_add_f32 v[20:21], v[20:21], v[36:37]
    v_pk_add_f32 v[22:23], v[22:23], v[38:39]
    v_pk_add_f32 v[24:25], v[24:25], v[40:41]
    v_pk_add_f32 v[26:27], v[26:27], v[42:43]
    v_pk_add_f32 v[28:29], v[28:29], v[44:45]
    v_pk_add_f32 v[30:31], v[30:31], v[46:47]
    v_pk_add_f32 v[32:33], v[32:33], v[48:49]
    v_add_f32 v34, v13, v15
    v_add_f32 v36, v14, v3
    v_cvt_pk_bf16_f32 v4, v18, v19
    v_lshlrev_b32 v18, 16, v4
    v_and_b32 v19, 0xffff0000, v4
    v_cvt_pk_bf16_f32 v4, v26, v27
    v_lshlrev_b32 v26, 16, v4
    v_and_b32 v27, 0xffff0000, v4
    v_add_f32 v18, 1.0, v18
    v_add_f32 v19, 1.0, v19
    v_cvt_pk_bf16_f32 v4, v18, v19
    v_lshlrev_b32 v18, 16, v4
    v_and_b32 v19, 0xffff0000, v4
    v_and_b32 v6, 0xffff0000, v8
    v_lshlrev_b32 v5, 16, v8
    v_mul_f32 v5, v5, v18
    v_mul_f32 v6, v6, v19
    v_cvt_pk_bf16_f32 v4, v5, v6
    v_lshlrev_b32 v5, 16, v4
    v_and_b32 v6, 0xffff0000, v4
    v_add_f32 v5, v5, v26
    v_add_f32 v6, v6, v27
    v_cvt_pk_bf16_f32 v8, v5, v6
    v_cvt_pk_bf16_f32 v4, v20, v21
    v_lshlrev_b32 v20, 16, v4
    v_and_b32 v21, 0xffff0000, v4
    v_cvt_pk_bf16_f32 v4, v28, v29
    v_lshlrev_b32 v28, 16, v4
    v_and_b32 v29, 0xffff0000, v4
    v_add_f32 v20, 1.0, v20
    v_add_f32 v21, 1.0, v21
    v_cvt_pk_bf16_f32 v4, v20, v21
    v_lshlrev_b32 v20, 16, v4
    v_and_b32 v21, 0xffff0000, v4
    v_and_b32 v6, 0xffff0000, v9
    v_lshlrev_b32 v5, 16, v9
    v_mul_f32 v5, v5, v20
    v_mul_f32 v6, v6, v21
    v_cvt_pk_bf16_f32 v4, v5, v6
    v_lshlrev_b32 v5, 16, v4
    v_and_b32 v6, 0xffff0000, v4
    v_add_f32 v5, v5, v28
    v_add_f32 v6, v6, v29
    v_cvt_pk_bf16_f32 v9, v5, v6
    ds_write_b64 v55, v[8:9] offset:2816
    v_cvt_pk_bf16_f32 v4, v22, v23
    v_lshlrev_b32 v22, 16, v4
    v_and_b32 v23, 0xffff0000, v4
    v_cvt_pk_bf16_f32 v4, v30, v31
    v_lshlrev_b32 v30, 16, v4
    v_and_b32 v31, 0xffff0000, v4
    v_add_f32 v22, 1.0, v22
    v_add_f32 v23, 1.0, v23
    v_cvt_pk_bf16_f32 v4, v22, v23
    v_lshlrev_b32 v22, 16, v4
    v_and_b32 v23, 0xffff0000, v4
    v_and_b32 v6, 0xffff0000, v10
    v_lshlrev_b32 v5, 16, v10
    v_mul_f32 v5, v5, v22
    v_mul_f32 v6, v6, v23
    v_cvt_pk_bf16_f32 v4, v5, v6
    v_lshlrev_b32 v5, 16, v4
    v_and_b32 v6, 0xffff0000, v4
    v_add_f32 v5, v5, v30
    v_add_f32 v6, v6, v31
    v_cvt_pk_bf16_f32 v10, v5, v6
    v_cvt_pk_bf16_f32 v4, v24, v25
    v_lshlrev_b32 v24, 16, v4
    v_and_b32 v25, 0xffff0000, v4
    v_cvt_pk_bf16_f32 v4, v32, v33
    v_lshlrev_b32 v32, 16, v4
    v_and_b32 v33, 0xffff0000, v4
    v_add_f32 v24, 1.0, v24
    v_add_f32 v25, 1.0, v25
    v_cvt_pk_bf16_f32 v4, v24, v25
    v_lshlrev_b32 v24, 16, v4
    v_and_b32 v25, 0xffff0000, v4
    v_and_b32 v6, 0xffff0000, v11
    v_lshlrev_b32 v5, 16, v11
    v_mul_f32 v5, v5, v24
    v_mul_f32 v6, v6, v25
    v_cvt_pk_bf16_f32 v4, v5, v6
    v_lshlrev_b32 v5, 16, v4
    v_and_b32 v6, 0xffff0000, v4
    v_add_f32 v5, v5, v32
    v_add_f32 v6, v6, v33
    v_cvt_pk_bf16_f32 v11, v5, v6
    ds_write_b64 v55, v[10:11] offset:3072
    v_cvt_pk_bf16_f32 v4, v34, v35
    v_lshlrev_b32 v34, 16, v4
    v_and_b32 v35, 0xffff0000, v4
    v_cvt_pk_bf16_f32 v4, v36, v37
    v_lshlrev_b32 v36, 16, v4
    v_and_b32 v37, 0xffff0000, v4
    v_add_f32 v34, 1.0, v34
    v_add_f32 v35, 1.0, v35
    v_cvt_pk_bf16_f32 v4, v34, v35
    v_lshlrev_b32 v34, 16, v4
    v_and_b32 v35, 0xffff0000, v4
    v_and_b32 v6, 0xffff0000, v12
    v_lshlrev_b32 v5, 16, v12
    v_mul_f32 v5, v5, v34
    v_mul_f32 v6, v6, v35
    v_cvt_pk_bf16_f32 v4, v5, v6
    v_lshlrev_b32 v5, 16, v4
    v_and_b32 v6, 0xffff0000, v4
    v_add_f32 v5, v5, v36
    v_add_f32 v6, v6, v37
    v_cvt_pk_bf16_f32 v12, v5, v6
    ds_write_b16 v7, v12 offset:3328
    ds_read_b128 v[12:15], v51 offset:0
    ds_read_b128 v[16:19], v51 offset:64
    ds_read_b128 v[20:23], v51 offset:128
    ds_read_b128 v[24:27], v51 offset:192
    ds_read_b128 v[28:31], v51 offset:256
    ds_read_b128 v[32:35], v51 offset:320
    ds_read_b128 v[36:39], v51 offset:384
    ds_read_b128 v[40:43], v51 offset:448
    ds_read_b128 v[44:47], v51 offset:512
    s_waitcnt lgkmcnt(8)
    v_mfma_f32_16x16x32_bf16 v[4:7], v[12:15], v[56:59], 0
    v_mfma_f32_16x16x32_bf16 v[8:11], v[12:15], v[60:63], 0
    s_waitcnt lgkmcnt(7)
    v_mfma_f32_16x16x32_bf16 v[4:7], v[16:19], v[64:67], v[4:7]
    v_mfma_f32_16x16x32_bf16 v[8:11], v[16:19], v[68:71], v[8:11]
    s_waitcnt lgkmcnt(6)
    v_mfma_f32_16x16x32_bf16 v[4:7], v[20:23], v[72:75], v[4:7]
    v_mfma_f32_16x16x32_bf16 v[8:11], v[20:23], v[76:79], v[8:11]
    s_waitcnt lgkmcnt(5)
    v_mfma_f32_16x16x32_bf16 v[4:7], v[24:27], v[80:83], v[4:7]
    v_mfma_f32_16x16x32_bf16 v[8:11], v[24:27], v[84:87], v[8:11]
    s_waitcnt lgkmcnt(4)
    v_mfma_f32_16x16x32_bf16 v[4:7], v[28:31], v[88:91], v[4:7]
    v_mfma_f32_16x16x32_bf16 v[8:11], v[28:31], v[92:95], v[8:11]
    s_waitcnt lgkmcnt(3)
    v_mfma_f32_16x16x32_bf16 v[4:7], v[32:35], v[96:99], v[4:7]
    v_mfma_f32_16x16x32_bf16 v[8:11], v[32:35], v[100:103], v[8:11]
    s_waitcnt lgkmcnt(2)
    v_mfma_f32_16x16x32_bf16 v[4:7], v[36:39], v[104:107], v[4:7]
    v_mfma_f32_16x16x32_bf16 v[8:11], v[36:39], v[108:111], v[8:11]
    s_waitcnt lgkmcnt(1)
    v_mfma_f32_16x16x32_bf16 v[4:7], v[40:43], v[112:115], v[4:7]
    v_mfma_f32_16x16x32_bf16 v[8:11], v[40:43], v[116:119], v[8:11]
    s_waitcnt lgkmcnt(0)
    v_mfma_f32_16x16x32_bf16 v[4:7], v[44:47], v[120:123], v[4:7]
    v_mfma_f32_16x16x32_bf16 v[8:11], v[44:47], v[124:127], v[8:11]
    s_nop 6
    v_mov_b32 v12, v4
    v_mov_b32_dpp v12, v5 quad_perm:[0,1,2,3] row_mask:0x2 bank_mask:0xf
    v_mov_b32_dpp v12, v8 quad_perm:[0,1,2,3] row_mask:0x4 bank_mask:0xf
    v_mov_b32_dpp v12, v9 quad_perm:[0,1,2,3] row_mask:0x8 bank_mask:0xf
    v_add_u32 v12, 4, v12
    v_bfi_b32 v12, 7, s89, v12
    buffer_store_dword v12, v53, s[12:15], 0 offen sc1
    s_mov_b32 s69, 0x8000
L_pl_30:
    buffer_load_dwordx2 v[6:7], v52, s[12:15], 0 offen sc1
    buffer_load_dwordx2 v[8:9], v52, s[12:15], s75 offen sc1
    s_waitcnt vmcnt(0)
    v_xor_b32 v6, s89, v6
    v_xor_b32 v7, s89, v7
    v_xor_b32 v8, s89, v8
    v_xor_b32 v9, s89, v9
    v_or_b32 v4, v6, v7
    v_or3_b32 v4, v4, v8, v9
    v_and_b32 v4, 7, v4
    v_cmp_ne_u16 vcc, 0, v4
    s_cbranch_vccz L_pd_31
    s_sub_u32 s69, s69, 1
    s_cbranch_scc0 L_pl_30
L_pd_31:
    v_add_f32 v6, v6, v8
    v_add_f32 v7, v7, v9
    v_cvt_pk_bf16_f32 v5, v6, v7
    buffer_load_dwordx4 v[64:67], v2, s[4:7], 0 offen offset:0 nt
    buffer_load_dwordx4 v[68:71], v2, s[4:7], 0 offen offset:1024 nt
    buffer_load_dwordx4 v[72:75], v2, s[4:7], 0 offen offset:2048 nt
    buffer_load_dwordx4 v[76:79], v2, s[4:7], 0 offen offset:3072 nt
    buffer_load_dwordx4 v[80:83], v2, s[4:7], s71 offen offset:0 nt
    buffer_load_dwordx4 v[84:87], v2, s[4:7], s71 offen offset:1024 nt
    buffer_load_dwordx4 v[88:91], v2, s[4:7], s71 offen offset:2048 nt
    buffer_load_dwordx4 v[92:95], v2, s[4:7], s71 offen offset:3072 nt
    buffer_load_dwordx4 v[96:99], v2, s[4:7], s72 offen offset:0 nt
    buffer_load_dwordx4 v[100:103], v2, s[4:7], s72 offen offset:1024 nt
    buffer_load_dwordx4 v[104:107], v2, s[4:7], s72 offen offset:2048 nt
    buffer_load_dwordx4 v[108:111], v2, s[4:7], s72 offen offset:3072 nt
    buffer_load_dwordx4 v[112:115], v2, s[4:7], s73 offen offset:0 nt
    buffer_load_dwordx4 v[116:119], v2, s[4:7], s73 offen offset:1024 nt
    buffer_load_dwordx4 v[120:123], v2, s[4:7], s73 offen offset:2048 nt
    buffer_load_dwordx4 v[124:127], v2, s[4:7], s73 offen offset:3072 nt
    v_lshlrev_b32 v3, 2, v1
    v_mov_b32 v6, 1
    ds_write_b32 v3, v5 offset:256
    s_waitcnt lgkmcnt(0)
    ds_write_b32 v0, v6 offset:0
    v_and_b32 v3, 15, v1
    v_lshlrev_b32 v3, 4, v3
    ds_read_b128 v[4:7], v3 offset:256
    s_waitcnt vmcnt(0) lgkmcnt(0)
    v_dot2_f32_bf16 v8, v64, v4, 0
    v_dot2_f32_bf16 v8, v65, v5, v8
    v_dot2_f32_bf16 v8, v66, v6, v8
    v_dot2_f32_bf16 v8, v67, v7, v8
    v_dot2_f32_bf16 v9, v68, v4, 0
    v_dot2_f32_bf16 v9, v69, v5, v9
    v_dot2_f32_bf16 v9, v70, v6, v9
    v_dot2_f32_bf16 v9, v71, v7, v9
    v_dot2_f32_bf16 v10, v72, v4, 0
    v_dot2_f32_bf16 v10, v73, v5, v10
    v_dot2_f32_bf16 v10, v74, v6, v10
    v_dot2_f32_bf16 v10, v75, v7, v10
    v_dot2_f32_bf16 v11, v76, v4, 0
    v_dot2_f32_bf16 v11, v77, v5, v11
    v_dot2_f32_bf16 v11, v78, v6, v11
    v_dot2_f32_bf16 v11, v79, v7, v11
    v_dot2_f32_bf16 v12, v80, v4, 0
    v_dot2_f32_bf16 v12, v81, v5, v12
    v_dot2_f32_bf16 v12, v82, v6, v12
    v_dot2_f32_bf16 v12, v83, v7, v12
    v_dot2_f32_bf16 v13, v84, v4, 0
    v_dot2_f32_bf16 v13, v85, v5, v13
    v_dot2_f32_bf16 v13, v86, v6, v13
    v_dot2_f32_bf16 v13, v87, v7, v13
    v_dot2_f32_bf16 v14, v88, v4, 0
    v_dot2_f32_bf16 v14, v89, v5, v14
    v_dot2_f32_bf16 v14, v90, v6, v14
    v_dot2_f32_bf16 v14, v91, v7, v14
    v_dot2_f32_bf16 v15, v92, v4, 0
    v_dot2_f32_bf16 v15, v93, v5, v15
    v_dot2_f32_bf16 v15, v94, v6, v15
    v_dot2_f32_bf16 v15, v95, v7, v15
    v_dot2_f32_bf16 v16, v96, v4, 0
    v_dot2_f32_bf16 v16, v97, v5, v16
    v_dot2_f32_bf16 v16, v98, v6, v16
    v_dot2_f32_bf16 v16, v99, v7, v16
    v_dot2_f32_bf16 v17, v100, v4, 0
    v_dot2_f32_bf16 v17, v101, v5, v17
    v_dot2_f32_bf16 v17, v102, v6, v17
    v_dot2_f32_bf16 v17, v103, v7, v17
    v_dot2_f32_bf16 v18, v104, v4, 0
    v_dot2_f32_bf16 v18, v105, v5, v18
    v_dot2_f32_bf16 v18, v106, v6, v18
    v_dot2_f32_bf16 v18, v107, v7, v18
    v_dot2_f32_bf16 v19, v108, v4, 0
    v_dot2_f32_bf16 v19, v109, v5, v19
    v_dot2_f32_bf16 v19, v110, v6, v19
    v_dot2_f32_bf16 v19, v111, v7, v19
    v_dot2_f32_bf16 v20, v112, v4, 0
    v_dot2_f32_bf16 v20, v113, v5, v20
    v_dot2_f32_bf16 v20, v114, v6, v20
    v_dot2_f32_bf16 v20, v115, v7, v20
    v_dot2_f32_bf16 v21, v116, v4, 0
    v_dot2_f32_bf16 v21, v117, v5, v21
    v_dot2_f32_bf16 v21, v118, v6, v21
    v_dot2_f32_bf16 v21, v119, v7, v21
    v_dot2_f32_bf16 v22, v120, v4, 0
    v_dot2_f32_bf16 v22, v121, v5, v22
    v_dot2_f32_bf16 v22, v122, v6, v22
    v_dot2_f32_bf16 v22, v123, v7, v22
    v_dot2_f32_bf16 v23, v124, v4, 0
    v_dot2_f32_bf16 v23, v125, v5, v23
    v_dot2_f32_bf16 v23, v126, v6, v23
    v_dot2_f32_bf16 v23, v127, v7, v23
    v_add_f32_dpp v24, v8, v8 row_ror:8 row_mask:0xf bank_mask:0x3
    v_add_f32_dpp v24, v16, v16 row_ror:8 row_mask:0xf bank_mask:0xc
    v_add_f32_dpp v25, v9, v9 row_ror:8 row_mask:0xf bank_mask:0x3
    v_add_f32_dpp v25, v17, v17 row_ror:8 row_mask:0xf bank_mask:0xc
    v_add_f32_dpp v26, v10, v10 row_ror:8 row_mask:0xf bank_mask:0x3
    v_add_f32_dpp v26, v18, v18 row_ror:8 row_mask:0xf bank_mask:0xc
    v_add_f32_dpp v27, v11, v11 row_ror:8 row_mask:0xf bank_mask:0x3
    v_add_f32_dpp v27, v19, v19 row_ror:8 row_mask:0xf bank_mask:0xc
    v_add_f32_dpp v28, v12, v12 row_ror:8 row_mask:0xf bank_mask:0x3
    v_add_f32_dpp v28, v20, v20 row_ror:8 row_mask:0xf bank_mask:0xc
    v_add_f32_dpp v29, v13, v13 row_ror:8 row_mask:0xf bank_mask:0x3
    v_add_f32_dpp v29, v21, v21 row_ror:8 row_mask:0xf bank_mask:0xc
    v_add_f32_dpp v30, v14, v14 row_ror:8 row_mask:0xf bank_mask:0x3
    v_add_f32_dpp v30, v22, v22 row_ror:8 row_mask:0xf bank_mask:0xc
    v_add_f32_dpp v31, v15, v15 row_ror:8 row_mask:0xf bank_mask:0x3
    v_add_f32_dpp v31, v23, v23 row_ror:8 row_mask:0xf bank_mask:0xc
    v_add_f32_dpp v8, v24, v24 row_shl:4 row_mask:0xf bank_mask:0x5
    v_add_f32_dpp v8, v28, v28 row_shr:4 row_mask:0xf bank_mask:0xa
    v_add_f32_dpp v9, v25, v25 row_shl:4 row_mask:0xf bank_mask:0x5
    v_add_f32_dpp v9, v29, v29 row_shr:4 row_mask:0xf bank_mask:0xa
    v_add_f32_dpp v10, v26, v26 row_shl:4 row_mask:0xf bank_mask:0x5
    v_add_f32_dpp v10, v30, v30 row_shr:4 row_mask:0xf bank_mask:0xa
    v_add_f32_dpp v11, v27, v27 row_shl:4 row_mask:0xf bank_mask:0x5
    v_add_f32_dpp v11, v31, v31 row_shr:4 row_mask:0xf bank_mask:0xa
    v_add_f32_dpp v12, v8, v8 quad_perm:[2,3,0,1] row_mask:0xf bank_mask:0xf
    v_add_f32_dpp v13, v9, v9 quad_perm:[2,3,0,1] row_mask:0xf bank_mask:0xf
    v_add_f32_dpp v14, v10, v10 quad_perm:[2,3,0,1] row_mask:0xf bank_mask:0xf
    v_add_f32_dpp v15, v11, v11 quad_perm:[2,3,0,1] row_mask:0xf bank_mask:0xf
    v_cndmask_b32 v8, v12, v14, s[90:91]
    v_cndmask_b32 v9, v13, v15, s[90:91]
    s_nop 0
    v_add_f32_dpp v12, v8, v8 quad_perm:[1,0,3,2] row_mask:0xf bank_mask:0xf
    v_add_f32_dpp v13, v9, v9 quad_perm:[1,0,3,2] row_mask:0xf bank_mask:0xf
    v_cndmask_b32 v16, v12, v13, s[92:93]
    v_cvt_pk_bf16_f32 v16, v16, v16
    v_and_b32 v16, 0xffff0000, v16
    v_mul_f32 v16, 0x3db504f3, v16
    v_cvt_pk_bf16_f32 v16, v16, v16
    v_and_b32 v16, 0xffff0000, v16
    v_mov_b32 v8, v16
    s_nop 1
    v_max_f32_dpp v8, v8, v8 row_ror:8 row_mask:0xf bank_mask:0xf
    s_nop 1
    v_max_f32_dpp v8, v8, v8 row_ror:4 row_mask:0xf bank_mask:0xf
    s_nop 1
    v_max_f32_dpp v8, v8, v8 row_ror:2 row_mask:0xf bank_mask:0xf
    s_nop 1
    v_max_f32_dpp v8, v8, v8 row_ror:1 row_mask:0xf bank_mask:0xf
    v_mov_b32 v9, v8
    s_nop 1
    v_permlane16_swap_b32 v8, v9
    v_max_f32 v8, v8, v9
    v_mov_b32 v9, v8
    s_nop 1
    v_permlane32_swap_b32 v8, v9
    v_max_f32 v8, v8, v9
    v_sub_f32 v9, v16, v8
    v_mul_f32 v9, 1069066811, v9
    v_exp_f32 v9, v9
    s_nop 1
    v_add_f32_dpp v9, v9, v9 row_ror:8 row_mask:0xf bank_mask:0xf
    s_nop 1
    v_add_f32_dpp v9, v9, v9 row_ror:4 row_mask:0xf bank_mask:0xf
    s_nop 1
    v_add_f32_dpp v9, v9, v9 row_ror:2 row_mask:0xf bank_mask:0xf
    s_nop 1
    v_add_f32_dpp v9, v9, v9 row_ror:1 row_mask:0xf bank_mask:0xf
    v_mov_b32 v10, v9
    s_nop 1
    v_permlane16_swap_b32 v9, v10
    v_add_f32 v9, v9, v10
    v_mov_b32 v10, v9
    s_nop 1
    v_permlane32_swap_b32 v9, v10
    v_add_f32 v9, v9, v10
    s_lshl_b32 s70, s60, 3
    v_mov_b32 v10, s70
    v_mov_b32 v11, 1
    s_mov_b64 exec, 1
    ds_write_b64 v10, v[8:9] offset:64
    ds_add_u32 v0, v11 offset:4
    s_mov_b64 exec, -1
    s_mov_b32 s69, 0x200000
L_sp_32:
    ds_read_b32 v3, v0 offset:4
    s_waitcnt lgkmcnt(0)
    v_readfirstlane_b32 s70, v3
    s_cmp_eq_u32 s70, 16
    s_cbranch_scc1 L_sd_33
    s_sub_u32 s69, s69, 1
    s_cbranch_scc0 L_sp_32
L_sd_33:
    v_and_b32 v3, 15, v1
    v_lshlrev_b32 v3, 3, v3
    ds_read_b64 v[8:9], v3 offset:64
    s_lshl_b32 s3, s94, 9
    s_add_u32 s3, s3, 1318912
    s_lshl_b32 s70, s66, 7
    s_add_u32 s70, s70, s3
    v_mov_b32 v14, s70
    v_mov_b32 v15, 2130706432
    v_cmp_eq_u32 vcc, 0, v1
    s_nop 1
    v_cndmask_b32 v14, v15, v14, vcc
    v_and_b32 v15, 3, v1
    v_lshl_add_u32 v15, v15, 7, s3
    v_mov_b32 v12, s89
    v_mov_b32 v13, s89
    s_waitcnt lgkmcnt(0)
    v_mov_b32 v10, v8
    s_nop 1
    v_max_f32_dpp v10, v10, v10 row_ror:8 row_mask:0xf bank_mask:0xf
    s_nop 1
    v_max_f32_dpp v10, v10, v10 row_ror:4 row_mask:0xf bank_mask:0xf
    s_nop 1
    v_max_f32_dpp v10, v10, v10 row_ror:2 row_mask:0xf bank_mask:0xf
    s_nop 1
    v_max_f32_dpp v10, v10, v10 row_ror:1 row_mask:0xf bank_mask:0xf
    v_sub_f32 v11, v8, v10
    v_mul_f32 v11, 1069066811, v11
    v_exp_f32 v11, v11
    s_nop 0
    v_mul_f32 v11, v11, v9
    s_nop 1
    v_add_f32_dpp v11, v11, v11 row_ror:8 row_mask:0xf bank_mask:0xf
    s_nop 1
    v_add_f32_dpp v11, v11, v11 row_ror:4 row_mask:0xf bank_mask:0xf
    s_nop 1
    v_add_f32_dpp v11, v11, v11 row_ror:2 row_mask:0xf bank_mask:0xf
    s_nop 1
    v_add_f32_dpp v11, v11, v11 row_ror:1 row_mask:0xf bank_mask:0xf
    v_or_b32 v10, s89, v10
    v_add_u32 v11, 4, v11
    v_bfi_b32 v11, 7, s89, v11
    buffer_store_dwordx4 v[10:13], v14, s[12:15], 0 offen sc1
    s_mov_b32 s69, 0x8000
L_pl_34:
    s_nop 0
    buffer_load_dwordx4 v[10:13], v15, s[12:15], 0 offen sc1
    s_waitcnt vmcnt(0)
    v_xor_b32 v11, s89, v11
    v_mov_b32 v4, v11
    v_and_b32 v4, 7, v4
    v_xor_b32 v10, s89, v10
    v_xor_b32 v12, s89, v12
    v_xor_b32 v13, s89, v13
    v_or3_b32 v5, v10, v12, v13
    v_or_b32 v4, v4, v5
    v_cmp_ne_u16 vcc, 0, v4
    s_cbranch_vccz L_pd_35
    s_sub_u32 s69, s69, 1
    s_cbranch_scc0 L_pl_34
L_pd_35:
    buffer_load_dwordx4 v[32:35], v2, s[8:11], 0 offen offset:0 nt
    buffer_load_dwordx4 v[36:39], v2, s[8:11], 0 offen offset:1024 nt
    buffer_load_dwordx4 v[40:43], v2, s[8:11], 0 offen offset:2048 nt
    buffer_load_dwordx4 v[44:47], v2, s[8:11], 0 offen offset:3072 nt
    buffer_load_dwordx4 v[48:51], v2, s[8:11], s71 offen offset:0 nt
    buffer_load_dwordx4 v[52:55], v2, s[8:11], s71 offen offset:1024 nt
    buffer_load_dwordx4 v[56:59], v2, s[8:11], s71 offen offset:2048 nt
    buffer_load_dwordx4 v[60:63], v2, s[8:11], s71 offen offset:3072 nt
    buffer_load_dwordx4 v[64:67], v2, s[8:11], s72 offen offset:0 nt
    buffer_load_dwordx4 v[68:71], v2, s[8:11], s72 offen offset:1024 nt
    buffer_load_dwordx4 v[72:75], v2, s[8:11], s72 offen offset:2048 nt
    buffer_load_dwordx4 v[76:79], v2, s[8:11], s72 offen offset:3072 nt
    buffer_load_dwordx4 v[80:83], v2, s[8:11], s73 offen offset:0 nt
    buffer_load_dwordx4 v[84:87], v2, s[8:11], s73 offen offset:1024 nt
    buffer_load_dwordx4 v[88:91], v2, s[8:11], s73 offen offset:2048 nt
    buffer_load_dwordx4 v[92:95], v2, s[8:11], s73 offen offset:3072 nt
    v_max_f32_dpp v8, v10, v10 quad_perm:[1,0,3,2] row_mask:0xf bank_mask:0xf
    s_nop 1
    v_max_f32_dpp v8, v8, v8 quad_perm:[2,3,0,1] row_mask:0xf bank_mask:0xf
    v_sub_f32 v9, v10, v8
    v_mul_f32 v9, 1069066811, v9
    v_exp_f32 v9, v9
    s_nop 0
    v_mul_f32 v9, v9, v11
    s_nop 1
    v_add_f32_dpp v9, v9, v9 quad_perm:[1,0,3,2] row_mask:0xf bank_mask:0xf
    s_nop 1
    v_add_f32_dpp v9, v9, v9 quad_perm:[2,3,0,1] row_mask:0xf bank_mask:0xf
    v_rcp_f32 v9, v9
    v_mov_b32 v6, 1
    ds_write_b64 v0, v[8:9] offset:16
    s_waitcnt lgkmcnt(0)
    ds_write_b32 v0, v6 offset:8
    v_sub_f32 v10, v16, v8
    v_mul_f32 v10, 1069066811, v10
    v_exp_f32 v10, v10
    s_nop 0
    v_mul_f32 v10, v10, v9
    v_cvt_pk_bf16_f32 v17, v10, 0
    v_lshlrev_b32 v18, 16, v17
    v_mov_b32 v8, 0
    v_mov_b32 v9, 0
    v_mov_b32 v10, 0
    v_mov_b32 v11, 0
    v_mov_b32 v12, 0
    v_mov_b32 v13, 0
    v_mov_b32 v14, 0
    v_mov_b32 v15, 0
    s_waitcnt vmcnt(15)
    v_dot2c_f32_bf16_dpp v8, v17, v32 row_newbcast:0 row_mask:0xf bank_mask:0xf
    v_dot2c_f32_bf16_dpp v9, v18, v32 row_newbcast:0 row_mask:0xf bank_mask:0xf
    v_dot2c_f32_bf16_dpp v10, v17, v33 row_newbcast:0 row_mask:0xf bank_mask:0xf
    v_dot2c_f32_bf16_dpp v11, v18, v33 row_newbcast:0 row_mask:0xf bank_mask:0xf
    v_dot2c_f32_bf16_dpp v12, v17, v34 row_newbcast:0 row_mask:0xf bank_mask:0xf
    v_dot2c_f32_bf16_dpp v13, v18, v34 row_newbcast:0 row_mask:0xf bank_mask:0xf
    v_dot2c_f32_bf16_dpp v14, v17, v35 row_newbcast:0 row_mask:0xf bank_mask:0xf
    v_dot2c_f32_bf16_dpp v15, v18, v35 row_newbcast:0 row_mask:0xf bank_mask:0xf
    s_waitcnt vmcnt(14)
    v_dot2c_f32_bf16_dpp v8, v17, v36 row_newbcast:1 row_mask:0xf bank_mask:0xf
    v_dot2c_f32_bf16_dpp v9, v18, v36 row_newbcast:1 row_mask:0xf bank_mask:0xf
    v_dot2c_f32_bf16_dpp v10, v17, v37 row_newbcast:1 row_mask:0xf bank_mask:0xf
    v_dot2c_f32_bf16_dpp v11, v18, v37 row_newbcast:1 row_mask:0xf bank_mask:0xf
    v_dot2c_f32_bf16_dpp v12, v17, v38 row_newbcast:1 row_mask:0xf bank_mask:0xf
    v_dot2c_f32_bf16_dpp v13, v18, v38 row_newbcast:1 row_mask:0xf bank_mask:0xf
    v_dot2c_f32_bf16_dpp v14, v17, v39 row_newbcast:1 row_mask:0xf bank_mask:0xf
    v_dot2c_f32_bf16_dpp v15, v18, v39 row_newbcast:1 row_mask:0xf bank_mask:0xf
    s_waitcnt vmcnt(13)
    v_dot2c_f32_bf16_dpp v8, v17, v40 row_newbcast:2 row_mask:0xf bank_mask:0xf
    v_dot2c_f32_bf16_dpp v9, v18, v40 row_newbcast:2 row_mask:0xf bank_mask:0xf
    v_dot2c_f32_bf16_dpp v10, v17, v41 row_newbcast:2 row_mask:0xf bank_mask:0xf
    v_dot2c_f32_bf16_dpp v11, v18, v41 row_newbcast:2 row_mask:0xf bank_mask:0xf
    v_dot2c_f32_bf16_dpp v12, v17, v42 row_newbcast:2 row_mask:0xf bank_mask:0xf
    v_dot2c_f32_bf16_dpp v13, v18, v42 row_newbcast:2 row_mask:0xf bank_mask:0xf
    v_dot2c_f32_bf16_dpp v14, v17, v43 row_newbcast:2 row_mask:0xf bank_mask:0xf
    v_dot2c_f32_bf16_dpp v15, v18, v43 row_newbcast:2 row_mask:0xf bank_mask:0xf
    s_waitcnt vmcnt(12)
    v_dot2c_f32_bf16_dpp v8, v17, v44 row_newbcast:3 row_mask:0xf bank_mask:0xf
    v_dot2c_f32_bf16_dpp v9, v18, v44 row_newbcast:3 row_mask:0xf bank_mask:0xf
    v_dot2c_f32_bf16_dpp v10, v17, v45 row_newbcast:3 row_mask:0xf bank_mask:0xf
    v_dot2c_f32_bf16_dpp v11, v18, v45 row_newbcast:3 row_mask:0xf bank_mask:0xf
    v_dot2c_f32_bf16_dpp v12, v17, v46 row_newbcast:3 row_mask:0xf bank_mask:0xf
    v_dot2c_f32_bf16_dpp v13, v18, v46 row_newbcast:3 row_mask:0xf bank_mask:0xf
    v_dot2c_f32_bf16_dpp v14, v17, v47 row_newbcast:3 row_mask:0xf bank_mask:0xf
    v_dot2c_f32_bf16_dpp v15, v18, v47 row_newbcast:3 row_mask:0xf bank_mask:0xf
    s_waitcnt vmcnt(11)
    v_dot2c_f32_bf16_dpp v8, v17, v48 row_newbcast:4 row_mask:0xf bank_mask:0xf
    v_dot2c_f32_bf16_dpp v9, v18, v48 row_newbcast:4 row_mask:0xf bank_mask:0xf
    v_dot2c_f32_bf16_dpp v10, v17, v49 row_newbcast:4 row_mask:0xf bank_mask:0xf
    v_dot2c_f32_bf16_dpp v11, v18, v49 row_newbcast:4 row_mask:0xf bank_mask:0xf
    v_dot2c_f32_bf16_dpp v12, v17, v50 row_newbcast:4 row_mask:0xf bank_mask:0xf
    v_dot2c_f32_bf16_dpp v13, v18, v50 row_newbcast:4 row_mask:0xf bank_mask:0xf
    v_dot2c_f32_bf16_dpp v14, v17, v51 row_newbcast:4 row_mask:0xf bank_mask:0xf
    v_dot2c_f32_bf16_dpp v15, v18, v51 row_newbcast:4 row_mask:0xf bank_mask:0xf
    s_waitcnt vmcnt(10)
    v_dot2c_f32_bf16_dpp v8, v17, v52 row_newbcast:5 row_mask:0xf bank_mask:0xf
    v_dot2c_f32_bf16_dpp v9, v18, v52 row_newbcast:5 row_mask:0xf bank_mask:0xf
    v_dot2c_f32_bf16_dpp v10, v17, v53 row_newbcast:5 row_mask:0xf bank_mask:0xf
    v_dot2c_f32_bf16_dpp v11, v18, v53 row_newbcast:5 row_mask:0xf bank_mask:0xf
    v_dot2c_f32_bf16_dpp v12, v17, v54 row_newbcast:5 row_mask:0xf bank_mask:0xf
    v_dot2c_f32_bf16_dpp v13, v18, v54 row_newbcast:5 row_mask:0xf bank_mask:0xf
    v_dot2c_f32_bf16_dpp v14, v17, v55 row_newbcast:5 row_mask:0xf bank_mask:0xf
    v_dot2c_f32_bf16_dpp v15, v18, v55 row_newbcast:5 row_mask:0xf bank_mask:0xf
    s_waitcnt vmcnt(9)
    v_dot2c_f32_bf16_dpp v8, v17, v56 row_newbcast:6 row_mask:0xf bank_mask:0xf
    v_dot2c_f32_bf16_dpp v9, v18, v56 row_newbcast:6 row_mask:0xf bank_mask:0xf
    v_dot2c_f32_bf16_dpp v10, v17, v57 row_newbcast:6 row_mask:0xf bank_mask:0xf
    v_dot2c_f32_bf16_dpp v11, v18, v57 row_newbcast:6 row_mask:0xf bank_mask:0xf
    v_dot2c_f32_bf16_dpp v12, v17, v58 row_newbcast:6 row_mask:0xf bank_mask:0xf
    v_dot2c_f32_bf16_dpp v13, v18, v58 row_newbcast:6 row_mask:0xf bank_mask:0xf
    v_dot2c_f32_bf16_dpp v14, v17, v59 row_newbcast:6 row_mask:0xf bank_mask:0xf
    v_dot2c_f32_bf16_dpp v15, v18, v59 row_newbcast:6 row_mask:0xf bank_mask:0xf
    s_waitcnt vmcnt(8)
    v_dot2c_f32_bf16_dpp v8, v17, v60 row_newbcast:7 row_mask:0xf bank_mask:0xf
    v_dot2c_f32_bf16_dpp v9, v18, v60 row_newbcast:7 row_mask:0xf bank_mask:0xf
    v_dot2c_f32_bf16_dpp v10, v17, v61 row_newbcast:7 row_mask:0xf bank_mask:0xf
    v_dot2c_f32_bf16_dpp v11, v18, v61 row_newbcast:7 row_mask:0xf bank_mask:0xf
    v_dot2c_f32_bf16_dpp v12, v17, v62 row_newbcast:7 row_mask:0xf bank_mask:0xf
    v_dot2c_f32_bf16_dpp v13, v18, v62 row_newbcast:7 row_mask:0xf bank_mask:0xf
    v_dot2c_f32_bf16_dpp v14, v17, v63 row_newbcast:7 row_mask:0xf bank_mask:0xf
    v_dot2c_f32_bf16_dpp v15, v18, v63 row_newbcast:7 row_mask:0xf bank_mask:0xf
    s_waitcnt vmcnt(7)
    v_dot2c_f32_bf16_dpp v8, v17, v64 row_newbcast:8 row_mask:0xf bank_mask:0xf
    v_dot2c_f32_bf16_dpp v9, v18, v64 row_newbcast:8 row_mask:0xf bank_mask:0xf
    v_dot2c_f32_bf16_dpp v10, v17, v65 row_newbcast:8 row_mask:0xf bank_mask:0xf
    v_dot2c_f32_bf16_dpp v11, v18, v65 row_newbcast:8 row_mask:0xf bank_mask:0xf
    v_dot2c_f32_bf16_dpp v12, v17, v66 row_newbcast:8 row_mask:0xf bank_mask:0xf
    v_dot2c_f32_bf16_dpp v13, v18, v66 row_newbcast:8 row_mask:0xf bank_mask:0xf
    v_dot2c_f32_bf16_dpp v14, v17, v67 row_newbcast:8 row_mask:0xf bank_mask:0xf
    v_dot2c_f32_bf16_dpp v15, v18, v67 row_newbcast:8 row_mask:0xf bank_mask:0xf
    s_waitcnt vmcnt(6)
    v_dot2c_f32_bf16_dpp v8, v17, v68 row_newbcast:9 row_mask:0xf bank_mask:0xf
    v_dot2c_f32_bf16_dpp v9, v18, v68 row_newbcast:9 row_mask:0xf bank_mask:0xf
    v_dot2c_f32_bf16_dpp v10, v17, v69 row_newbcast:9 row_mask:0xf bank_mask:0xf
    v_dot2c_f32_bf16_dpp v11, v18, v69 row_newbcast:9 row_mask:0xf bank_mask:0xf
    v_dot2c_f32_bf16_dpp v12, v17, v70 row_newbcast:9 row_mask:0xf bank_mask:0xf
    v_dot2c_f32_bf16_dpp v13, v18, v70 row_newbcast:9 row_mask:0xf bank_mask:0xf
    v_dot2c_f32_bf16_dpp v14, v17, v71 row_newbcast:9 row_mask:0xf bank_mask:0xf
    v_dot2c_f32_bf16_dpp v15, v18, v71 row_newbcast:9 row_mask:0xf bank_mask:0xf
    s_waitcnt vmcnt(5)
    v_dot2c_f32_bf16_dpp v8, v17, v72 row_newbcast:10 row_mask:0xf bank_mask:0xf
    v_dot2c_f32_bf16_dpp v9, v18, v72 row_newbcast:10 row_mask:0xf bank_mask:0xf
    v_dot2c_f32_bf16_dpp v10, v17, v73 row_newbcast:10 row_mask:0xf bank_mask:0xf
    v_dot2c_f32_bf16_dpp v11, v18, v73 row_newbcast:10 row_mask:0xf bank_mask:0xf
    v_dot2c_f32_bf16_dpp v12, v17, v74 row_newbcast:10 row_mask:0xf bank_mask:0xf
    v_dot2c_f32_bf16_dpp v13, v18, v74 row_newbcast:10 row_mask:0xf bank_mask:0xf
    v_dot2c_f32_bf16_dpp v14, v17, v75 row_newbcast:10 row_mask:0xf bank_mask:0xf
    v_dot2c_f32_bf16_dpp v15, v18, v75 row_newbcast:10 row_mask:0xf bank_mask:0xf
    s_waitcnt vmcnt(4)
    v_dot2c_f32_bf16_dpp v8, v17, v76 row_newbcast:11 row_mask:0xf bank_mask:0xf
    v_dot2c_f32_bf16_dpp v9, v18, v76 row_newbcast:11 row_mask:0xf bank_mask:0xf
    v_dot2c_f32_bf16_dpp v10, v17, v77 row_newbcast:11 row_mask:0xf bank_mask:0xf
    v_dot2c_f32_bf16_dpp v11, v18, v77 row_newbcast:11 row_mask:0xf bank_mask:0xf
    v_dot2c_f32_bf16_dpp v12, v17, v78 row_newbcast:11 row_mask:0xf bank_mask:0xf
    v_dot2c_f32_bf16_dpp v13, v18, v78 row_newbcast:11 row_mask:0xf bank_mask:0xf
    v_dot2c_f32_bf16_dpp v14, v17, v79 row_newbcast:11 row_mask:0xf bank_mask:0xf
    v_dot2c_f32_bf16_dpp v15, v18, v79 row_newbcast:11 row_mask:0xf bank_mask:0xf
    s_waitcnt vmcnt(3)
    v_dot2c_f32_bf16_dpp v8, v17, v80 row_newbcast:12 row_mask:0xf bank_mask:0xf
    v_dot2c_f32_bf16_dpp v9, v18, v80 row_newbcast:12 row_mask:0xf bank_mask:0xf
    v_dot2c_f32_bf16_dpp v10, v17, v81 row_newbcast:12 row_mask:0xf bank_mask:0xf
    v_dot2c_f32_bf16_dpp v11, v18, v81 row_newbcast:12 row_mask:0xf bank_mask:0xf
    v_dot2c_f32_bf16_dpp v12, v17, v82 row_newbcast:12 row_mask:0xf bank_mask:0xf
    v_dot2c_f32_bf16_dpp v13, v18, v82 row_newbcast:12 row_mask:0xf bank_mask:0xf
    v_dot2c_f32_bf16_dpp v14, v17, v83 row_newbcast:12 row_mask:0xf bank_mask:0xf
    v_dot2c_f32_bf16_dpp v15, v18, v83 row_newbcast:12 row_mask:0xf bank_mask:0xf
    s_waitcnt vmcnt(2)
    v_dot2c_f32_bf16_dpp v8, v17, v84 row_newbcast:13 row_mask:0xf bank_mask:0xf
    v_dot2c_f32_bf16_dpp v9, v18, v84 row_newbcast:13 row_mask:0xf bank_mask:0xf
    v_dot2c_f32_bf16_dpp v10, v17, v85 row_newbcast:13 row_mask:0xf bank_mask:0xf
    v_dot2c_f32_bf16_dpp v11, v18, v85 row_newbcast:13 row_mask:0xf bank_mask:0xf
    v_dot2c_f32_bf16_dpp v12, v17, v86 row_newbcast:13 row_mask:0xf bank_mask:0xf
    v_dot2c_f32_bf16_dpp v13, v18, v86 row_newbcast:13 row_mask:0xf bank_mask:0xf
    v_dot2c_f32_bf16_dpp v14, v17, v87 row_newbcast:13 row_mask:0xf bank_mask:0xf
    v_dot2c_f32_bf16_dpp v15, v18, v87 row_newbcast:13 row_mask:0xf bank_mask:0xf
    s_waitcnt vmcnt(1)
    v_dot2c_f32_bf16_dpp v8, v17, v88 row_newbcast:14 row_mask:0xf bank_mask:0xf
    v_dot2c_f32_bf16_dpp v9, v18, v88 row_newbcast:14 row_mask:0xf bank_mask:0xf
    v_dot2c_f32_bf16_dpp v10, v17, v89 row_newbcast:14 row_mask:0xf bank_mask:0xf
    v_dot2c_f32_bf16_dpp v11, v18, v89 row_newbcast:14 row_mask:0xf bank_mask:0xf
    v_dot2c_f32_bf16_dpp v12, v17, v90 row_newbcast:14 row_mask:0xf bank_mask:0xf
    v_dot2c_f32_bf16_dpp v13, v18, v90 row_newbcast:14 row_mask:0xf bank_mask:0xf
    v_dot2c_f32_bf16_dpp v14, v17, v91 row_newbcast:14 row_mask:0xf bank_mask:0xf
    v_dot2c_f32_bf16_dpp v15, v18, v91 row_newbcast:14 row_mask:0xf bank_mask:0xf
    s_waitcnt vmcnt(0)
    v_dot2c_f32_bf16_dpp v8, v17, v92 row_newbcast:15 row_mask:0xf bank_mask:0xf
    v_dot2c_f32_bf16_dpp v9, v18, v92 row_newbcast:15 row_mask:0xf bank_mask:0xf
    v_dot2c_f32_bf16_dpp v10, v17, v93 row_newbcast:15 row_mask:0xf bank_mask:0xf
    v_dot2c_f32_bf16_dpp v11, v18, v93 row_newbcast:15 row_mask:0xf bank_mask:0xf
    v_dot2c_f32_bf16_dpp v12, v17, v94 row_newbcast:15 row_mask:0xf bank_mask:0xf
    v_dot2c_f32_bf16_dpp v13, v18, v94 row_newbcast:15 row_mask:0xf bank_mask:0xf
    v_dot2c_f32_bf16_dpp v14, v17, v95 row_newbcast:15 row_mask:0xf bank_mask:0xf
    v_dot2c_f32_bf16_dpp v15, v18, v95 row_newbcast:15 row_mask:0xf bank_mask:0xf
    v_permlane32_swap_b32 v8, v12
    v_permlane32_swap_b32 v9, v13
    v_permlane32_swap_b32 v10, v14
    v_permlane32_swap_b32 v11, v15
    v_add_f32 v8, v8, v12
    v_add_f32 v9, v9, v13
    v_add_f32 v10, v10, v14
    v_add_f32 v11, v11, v15
    s_nop 0
    v_permlane16_swap_b32 v8, v10
    v_permlane16_swap_b32 v9, v11
    v_add_f32 v8, v8, v10
    v_add_f32 v9, v9, v11
    v_and_b32 v10, 15, v1
    v_lshrrev_b32 v11, 4, v1
    v_lshlrev_b32 v10, 5, v10
    v_lshl_add_u32 v10, v11, 3, v10
    s_lshl_b32 s70, s60, 9
    v_add_u32 v10, s70, v10
    v_mov_b32 v11, 1
    ds_write_b64 v10, v[8:9] offset:10240
    s_mov_b64 exec, 1
    ds_add_u32 v0, v11 offset:12
    s_mov_b64 exec, -1
    s_mov_b32 s69, 0x200000
L_sp_36:
    ds_read_b32 v3, v0 offset:12
    s_waitcnt lgkmcnt(0)
    v_readfirstlane_b32 s70, v3
    s_cmp_eq_u32 s70, 16
    s_cbranch_scc1 L_sd_37
    s_sub_u32 s69, s69, 1
    s_cbranch_scc0 L_sp_36
L_sd_37:
    v_lshlrev_b32 v3, 3, v1
    ds_read_b64 v[32:33], v3 offset:10240
    ds_read_b64 v[34:35], v3 offset:10752
    ds_read_b64 v[36:37], v3 offset:11264
    ds_read_b64 v[38:39], v3 offset:11776
    ds_read_b64 v[40:41], v3 offset:12288
    ds_read_b64 v[42:43], v3 offset:12800
    ds_read_b64 v[44:45], v3 offset:13312
    ds_read_b64 v[46:47], v3 offset:13824
    ds_read_b64 v[48:49], v3 offset:14336
    ds_read_b64 v[50:51], v3 offset:14848
    ds_read_b64 v[52:53], v3 offset:15360
    ds_read_b64 v[54:55], v3 offset:15872
    ds_read_b64 v[56:57], v3 offset:16384
    ds_read_b64 v[58:59], v3 offset:16896
    ds_read_b64 v[60:61], v3 offset:17408
    ds_read_b64 v[62:63], v3 offset:17920
    s_lshl_b32 s3, s63, 3
    s_add_u32 s3, s3, s64
    s_lshl_b32 s3, s3, 9
    s_add_u32 s3, s3, 131072
    v_add_u32 v3, s3, v3
    s_waitcnt lgkmcnt(0)
    v_pk_add_f32 v[32:33], v[32:33], v[48:49]
    v_pk_add_f32 v[34:35], v[34:35], v[50:51]
    v_pk_add_f32 v[36:37], v[36:37], v[52:53]
    v_pk_add_f32 v[38:39], v[38:39], v[54:55]
    v_pk_add_f32 v[40:41], v[40:41], v[56:57]
    v_pk_add_f32 v[42:43], v[42:43], v[58:59]
    v_pk_add_f32 v[44:45], v[44:45], v[60:61]
    v_pk_add_f32 v[46:47], v[46:47], v[62:63]
    v_pk_add_f32 v[32:33], v[32:33], v[40:41]
    v_pk_add_f32 v[34:35], v[34:35], v[42:43]
    v_pk_add_f32 v[36:37], v[36:37], v[44:45]
    v_pk_add_f32 v[38:39], v[38:39], v[46:47]
    v_pk_add_f32 v[32:33], v[32:33], v[36:37]
    v_pk_add_f32 v[34:35], v[34:35], v[38:39]
    v_pk_add_f32 v[32:33], v[32:33], v[34:35]
    v_add_u32 v32, 4, v32
    v_bfi_b32 v32, 7, s89, v32
    v_add_u32 v33, 4, v33
    v_bfi_b32 v33, 7, s89, v33
    buffer_store_dwordx2 v[32:33], v3, s[12:15], 0 offen sc1
    s_cmp_eq_u32 s67, 2
    s_cbranch_scc1 L_R
    s_cmp_eq_u32 s67, 1
    s_cbranch_scc0 L_Bend
    s_lshr_b32 s3, s68, 1
    s_lshl_b32 s3, s3, 12
    s_and_b32 s70, s68, 1
    s_lshl_b32 s70, s70, 8
    s_add_u32 s3, s3, s70
    s_add_u32 s3, s3, 131072
    v_lshrrev_b32 v5, 4, v1
    v_and_b32 v6, 15, v1
    v_lshlrev_b32 v3, 9, v5
    v_lshl_add_u32 v3, v6, 4, v3
    v_add_u32 v3, s3, v3
    v_lshlrev_b32 v6, 3, v6
    v_and_b32 v7, 1, v5
    v_lshl_add_u32 v6, v7, 2, v6
    v_lshrrev_b32 v5, 1, v5
    v_lshl_add_u32 v6, v5, 7, v6
    s_mov_b32 s69, 0x8000
L_pl_38:
    buffer_load_dwordx4 v[40:43], v3, s[12:15], 0 offen sc1
    buffer_load_dwordx4 v[44:47], v3, s[12:15], 0 offen offset:2048 sc1
    s_waitcnt vmcnt(0)
    v_xor_b32 v40, s89, v40
    v_xor_b32 v41, s89, v41
    v_xor_b32 v42, s89, v42
    v_xor_b32 v43, s89, v43
    v_xor_b32 v44, s89, v44
    v_xor_b32 v45, s89, v45
    v_xor_b32 v46, s89, v46
    v_xor_b32 v47, s89, v47
    v_or_b32 v4, v40, v41
    v_or3_b32 v4, v4, v42, v43
    v_or3_b32 v4, v4, v44, v45
    v_or3_b32 v4, v4, v46, v47
    v_and_b32 v4, 7, v4
    v_cmp_ne_u16 vcc, 0, v4
    s_cbranch_vccz L_pd_39
    s_sub_u32 s69, s69, 1
    s_cbranch_scc0 L_pl_38
L_pd_39:
    v_permlane32_swap_b32 v40, v44
    v_permlane32_swap_b32 v41, v45
    v_permlane32_swap_b32 v42, v46
    v_permlane32_swap_b32 v43, v47
    v_add_f32 v8, v40, v44
    v_add_f32 v9, v41, v45
    v_add_f32 v10, v42, v46
    v_add_f32 v11, v43, v47
    s_nop 0
    v_permlane16_swap_b32 v8, v10
    v_permlane16_swap_b32 v9, v11
    v_add_f32 v8, v8, v10
    v_add_f32 v9, v9, v11
    v_cvt_pk_bf16_f32 v8, v8, v9
    ds_write_b32 v6, v8 offset:5120
    s_waitcnt lgkmcnt(0)
    s_barrier
L_Bend:
    s_endpgm
L_R:
    s_setprio 3
    s_mov_b32 s20, s32
    s_mov_b32 s21, s33
    s_mov_b32 s22, 2304
    s_mov_b32 s23, 0x20000
    s_mov_b32 s28, s54
    s_mov_b32 s29, s55
    s_mov_b32 s30, 2304
    s_mov_b32 s31, 0x20000
    s_lshl_b32 s3, s68, 6
    v_and_b32 v5, 7, v1
    v_lshl_add_u32 v5, v5, 3, s3
    s_mov_b32 s74, 23040
    s_mov_b32 s75, 36864
    s_mov_b32 s76, 50688
    v_lshlrev_b32 v6, 1, v5
    buffer_load_dwordx2 v[8:9], v5, s[20:23], 0 offen
    s_mov_b32 s69, 0x8000
L_pl_40:
    buffer_load_dwordx4 v[24:27], v6, s[12:15], s72 offen offset:1024 sc1
    buffer_load_dwordx4 v[28:31], v6, s[12:15], s74 offen sc1
    buffer_load_dwordx4 v[32:35], v6, s[12:15], s75 offen sc1
    buffer_load_dwordx4 v[36:39], v6, s[12:15], s76 offen sc1
    s_waitcnt vmcnt(0)
    v_xor_b32 v24, s89, v24
    v_xor_b32 v25, s89, v25
    v_xor_b32 v26, s89, v26
    v_xor_b32 v27, s89, v27
    v_xor_b32 v28, s89, v28
    v_xor_b32 v29, s89, v29
    v_xor_b32 v30, s89, v30
    v_xor_b32 v31, s89, v31
    v_xor_b32 v32, s89, v32
    v_xor_b32 v33, s89, v33
    v_xor_b32 v34, s89, v34
    v_xor_b32 v35, s89, v35
    v_xor_b32 v36, s89, v36
    v_xor_b32 v37, s89, v37
    v_xor_b32 v38, s89, v38
    v_xor_b32 v39, s89, v39
    v_or_b32 v4, v24, v25
    v_or3_b32 v4, v4, v26, v27
    v_or3_b32 v4, v4, v28, v29
    v_or3_b32 v4, v4, v30, v31
    v_or3_b32 v4, v4, v32, v33
    v_or3_b32 v4, v4, v34, v35
    v_or3_b32 v4, v4, v36, v37
    v_or3_b32 v4, v4, v38, v39
    v_and_b32 v4, 7, v4
    v_cmp_ne_u16 vcc, 0, v4
    s_cbranch_vccz L_pd_41
    s_sub_u32 s69, s69, 1
    s_cbranch_scc0 L_pl_40
L_pd_41:
    v_add_f32 v24, v24, v32
    v_add_f32 v25, v25, v33
    v_add_f32 v26, v26, v34
    v_add_f32 v27, v27, v35
    v_add_f32 v28, v28, v36
    v_add_f32 v29, v29, v37
    v_add_f32 v30, v30, v38
    v_add_f32 v31, v31, v39
    v_cvt_pk_bf16_f32 v4, v24, v25
    v_lshlrev_b32 v24, 16, v4
    v_and_b32 v25, 0xffff0000, v4
    v_cvt_pk_bf16_f32 v4, v26, v27
    v_lshlrev_b32 v26, 16, v4
    v_and_b32 v27, 0xffff0000, v4
    v_cvt_pk_bf16_f32 v4, v28, v29
    v_lshlrev_b32 v28, 16, v4
    v_and_b32 v29, 0xffff0000, v4
    v_cvt_pk_bf16_f32 v4, v30, v31
    v_lshlrev_b32 v30, 16, v4
    v_and_b32 v31, 0xffff0000, v4
    v_and_b32 v21, 0xffff0000, v8
    v_lshlrev_b32 v20, 16, v8
    v_and_b32 v23, 0xffff0000, v9
    v_lshlrev_b32 v22, 16, v9
    v_mov_b32 v6, 2130706432
    v_lshrrev_b32 v4, 1, v1
    s_sub_u32 s3, s60, 1
    v_cmp_eq_u32 vcc, s3, v4
    s_nop 1
    v_cndmask_b32 v5, v6, v5, vcc
    s_cmp_eq_u32 s60, 1
    s_cselect_b32 s3, 8, 0
    v_cmp_gt_u32 vcc, s3, v1
    s_lshl_b32 s3, s68, 7
    s_add_u32 s3, s3, 106496
    v_lshl_add_u32 v7, v1, 4, s3
    v_cndmask_b32 v7, v6, v7, vcc
    s_cmp_eq_u32 s60, 1
    s_cbranch_scc1 L_Rb
    s_lshl_b32 s3, s68, 7
    s_add_u32 s3, s3, 106496
    v_and_b32 v7, 7, v1
    v_lshl_add_u32 v7, v7, 4, s3
    s_mov_b32 s69, 0x8000
L_pl_42:
    buffer_load_dwordx4 v[20:23], v7, s[12:15], 0 offen sc1
    s_waitcnt vmcnt(0)
    v_xor_b32 v20, s89, v20
    v_xor_b32 v21, s89, v21
    v_xor_b32 v22, s89, v22
    v_xor_b32 v23, s89, v23
    v_or_b32 v4, v20, v21
    v_or3_b32 v4, v4, v22, v23
    v_cmp_ne_u16 vcc, 0, v4
    s_cbranch_vccz L_pd_43
    s_sub_u32 s69, s69, 1
    s_cbranch_scc0 L_pl_42
L_pd_43:
    s_branch L_Rc
L_Rb:
    v_lshrrev_b32 v3, 3, v1
    v_mul_u32_u24 v3, 4608, v3
    v_and_b32 v4, 7, v1
    v_lshl_add_u32 v3, v4, 4, v3
    s_lshl_b32 s70, s68, 7
    s_add_u32 s70, s70, 262144
    v_add_u32 v3, s70, v3
    s_mov_b32 s4, 36864
    s_mov_b32 s5, 73728
    s_mov_b32 s6, 110592
    s_mov_b32 s7, 147456
    s_mov_b32 s8, 184320
    s_mov_b32 s9, 221184
    s_mov_b32 s10, 258048
    v_and_b32 v45, 31, v1
    s_add_u32 s70, s70, 0
    v_lshl_add_u32 v45, v45, 2, s70
    s_mov_b32 s69, 0x8000
L_pl_44:
    buffer_load_dword v47, v45, s[12:15], 0 offen sc1
    s_waitcnt vmcnt(0)
    v_xor_b32 v47, s89, v47
    v_mov_b32 v4, v47
    v_and_b32 v4, 7, v4
    v_cmp_ne_u16 vcc, 0, v4
    s_cbranch_vccz L_pd_45
    s_sub_u32 s69, s69, 1
    s_cbranch_scc0 L_pl_44
L_pd_45:
    s_mov_b32 s69, 0x8000
L_pl_46:
    buffer_load_dwordx4 v[48:51], v3, s[12:15], 0 offen sc1
    buffer_load_dwordx4 v[52:55], v3, s[12:15], s4 offen sc1
    buffer_load_dwordx4 v[56:59], v3, s[12:15], s5 offen sc1
    buffer_load_dwordx4 v[60:63], v3, s[12:15], s6 offen sc1
    buffer_load_dwordx4 v[64:67], v3, s[12:15], s7 offen sc1
    buffer_load_dwordx4 v[68:71], v3, s[12:15], s8 offen sc1
    buffer_load_dwordx4 v[72:75], v3, s[12:15], s9 offen sc1
    buffer_load_dwordx4 v[76:79], v3, s[12:15], s10 offen sc1
    s_waitcnt vmcnt(0)
    v_xor_b32 v48, s89, v48
    v_xor_b32 v49, s89, v49
    v_xor_b32 v50, s89, v50
    v_xor_b32 v51, s89, v51
    v_xor_b32 v52, s89, v52
    v_xor_b32 v53, s89, v53
    v_xor_b32 v54, s89, v54
    v_xor_b32 v55, s89, v55
    v_xor_b32 v56, s89, v56
    v_xor_b32 v57, s89, v57
    v_xor_b32 v58, s89, v58
    v_xor_b32 v59, s89, v59
    v_xor_b32 v60, s89, v60
    v_xor_b32 v61, s89, v61
    v_xor_b32 v62, s89, v62
    v_xor_b32 v63, s89, v63
    v_xor_b32 v64, s89, v64
    v_xor_b32 v65, s89, v65
    v_xor_b32 v66, s89, v66
    v_xor_b32 v67, s89, v67
    v_xor_b32 v68, s89, v68
    v_xor_b32 v69, s89, v69
    v_xor_b32 v70, s89, v70
    v_xor_b32 v71, s89, v71
    v_xor_b32 v72, s89, v72
    v_xor_b32 v73, s89, v73
    v_xor_b32 v74, s89, v74
    v_xor_b32 v75, s89, v75
    v_xor_b32 v76, s89, v76
    v_xor_b32 v77, s89, v77
    v_xor_b32 v78, s89, v78
    v_xor_b32 v79, s89, v79
    v_or_b32 v4, v48, v49
    v_or3_b32 v4, v4, v50, v51
    v_or3_b32 v4, v4, v52, v53
    v_or3_b32 v4, v4, v54, v55
    v_or3_b32 v4, v4, v56, v57
    v_or3_b32 v4, v4, v58, v59
    v_or3_b32 v4, v4, v60, v61
    v_or3_b32 v4, v4, v62, v63
    v_or3_b32 v4, v4, v64, v65
    v_or3_b32 v4, v4, v66, v67
    v_or3_b32 v4, v4, v68, v69
    v_or3_b32 v4, v4, v70, v71
    v_or3_b32 v4, v4, v72, v73
    v_or3_b32 v4, v4, v74, v75
    v_or3_b32 v4, v4, v76, v77
    v_or3_b32 v4, v4, v78, v79
    v_and_b32 v4, 7, v4
    v_cmp_ne_u16 vcc, 0, v4
    s_cbranch_vccz L_pd_47
    s_sub_u32 s69, s69, 1
    s_cbranch_scc0 L_pl_46
L_pd_47:
    v_pk_add_f32 v[32:33], v[48:49], v[52:53]
    v_pk_add_f32 v[34:35], v[50:51], v[54:55]
    v_pk_add_f32 v[36:37], v[56:57], v[60:61]
    v_pk_add_f32 v[38:39], v[58:59], v[62:63]
    v_pk_add_f32 v[40:41], v[64:65], v[68:69]
    v_pk_add_f32 v[42:43], v[66:67], v[70:71]
    v_pk_add_f32 v[44:45], v[72:73], v[76:77]
    v_pk_add_f32 v[46:47], v[74:75], v[78:79]
    v_pk_add_f32 v[32:33], v[32:33], v[40:41]
    v_pk_add_f32 v[34:35], v[34:35], v[42:43]
    v_pk_add_f32 v[36:37], v[36:37], v[44:45]
    v_pk_add_f32 v[38:39], v[38:39], v[46:47]
    v_pk_add_f32 v[32:33], v[32:33], v[36:37]
    v_pk_add_f32 v[34:35], v[34:35], v[38:39]
    s_nop 0
    v_add_f32_dpp v32, v32, v32 row_ror:8 row_mask:0xf bank_mask:0xf
    v_add_f32_dpp v33, v33, v33 row_ror:8 row_mask:0xf bank_mask:0xf
    v_add_f32_dpp v34, v34, v34 row_ror:8 row_mask:0xf bank_mask:0xf
    v_add_f32_dpp v35, v35, v35 row_ror:8 row_mask:0xf bank_mask:0xf
    v_mov_b32 v36, v32
    v_mov_b32 v37, v33
    v_mov_b32 v38, v34
    v_mov_b32 v39, v35
    v_permlane16_swap_b32 v32, v36
    v_permlane16_swap_b32 v33, v37
    v_permlane16_swap_b32 v34, v38
    v_permlane16_swap_b32 v35, v39
    v_add_f32 v32, v32, v36
    v_add_f32 v33, v33, v37
    v_add_f32 v34, v34, v38
    v_add_f32 v35, v35, v39
    v_mov_b32 v36, v32
    v_mov_b32 v37, v33
    v_mov_b32 v38, v34
    v_mov_b32 v39, v35
    v_permlane32_swap_b32 v32, v36
    v_permlane32_swap_b32 v33, v37
    v_permlane32_swap_b32 v34, v38
    v_permlane32_swap_b32 v35, v39
    v_add_f32 v32, v32, v36
    v_add_f32 v33, v33, v37
    v_add_f32 v34, v34, v38
    v_add_f32 v35, v35, v39
    v_cvt_pk_bf16_f32 v4, v32, v33
    v_lshlrev_b32 v32, 16, v4
    v_and_b32 v33, 0xffff0000, v4
    v_cvt_pk_bf16_f32 v4, v34, v35
    v_lshlrev_b32 v34, 16, v4
    v_and_b32 v35, 0xffff0000, v4
    v_mul_f32 v32, v32, v24
    v_mul_f32 v33, v33, v25
    v_mul_f32 v34, v34, v26
    v_mul_f32 v35, v35, v27
    v_cvt_pk_bf16_f32 v4, v32, v33
    v_lshlrev_b32 v32, 16, v4
    v_and_b32 v33, 0xffff0000, v4
    v_cvt_pk_bf16_f32 v4, v34, v35
    v_lshlrev_b32 v34, 16, v4
    v_and_b32 v35, 0xffff0000, v4
    v_add_f32 v20, v20, v32
    v_add_f32 v21, v21, v33
    v_add_f32 v22, v22, v34
    v_add_f32 v23, v23, v35
    v_cvt_pk_bf16_f32 v8, v20, v21
    v_cvt_pk_bf16_f32 v9, v22, v23
    v_and_b32 v21, 0xffff0000, v8
    v_lshlrev_b32 v20, 16, v8
    v_and_b32 v23, 0xffff0000, v9
    v_lshlrev_b32 v22, 16, v9
    v_or_b32 v8, s89, v20
    v_or_b32 v9, s89, v21
    v_or_b32 v10, s89, v22
    v_or_b32 v11, s89, v23
    buffer_store_dwordx4 v[8:11], v7, s[12:15], 0 offen sc1
L_Rc:
    v_lshrrev_b32 v3, 1, v1
    v_mul_u32_u24 v3, 4608, v3
    v_and_b32 v4, 1, v1
    v_lshl_add_u32 v3, v4, 4, v3
    s_lshl_b32 s70, s68, 7
    s_add_u32 s70, s70, 589792
    s_lshl_b32 s3, s60, 5
    s_add_u32 s70, s70, s3
    v_add_u32 v3, s70, v3
    v_cmp_lt_u32 vcc, 31, v1
    v_subrev_u32 v46, 73728, v3
    s_nop 0
    v_cndmask_b32 v46, v3, v46, vcc
    s_mov_b32 s4, 147456
    s_mov_b32 s5, 294912
    s_mov_b32 s6, 442368
    s_mov_b32 s7, 589824
    v_and_b32 v45, 7, v1
    s_add_u32 s70, s70, 331776
    v_lshl_add_u32 v45, v45, 2, s70
    s_mov_b32 s69, 0x8000
L_pl_48:
    buffer_load_dword v47, v45, s[12:15], 0 offen sc1
    s_waitcnt vmcnt(0)
    v_xor_b32 v47, s89, v47
    v_mov_b32 v4, v47
    v_and_b32 v4, 7, v4
    v_cmp_ne_u16 vcc, 0, v4
    s_cbranch_vccz L_pd_49
    s_sub_u32 s69, s69, 1
    s_cbranch_scc0 L_pl_48
L_pd_49:
    s_mov_b32 s69, 0x8000
L_pl_50:
    buffer_load_dwordx4 v[48:51], v3, s[12:15], 0 offen sc1
    buffer_load_dwordx4 v[52:55], v3, s[12:15], s4 offen sc1
    buffer_load_dwordx4 v[56:59], v3, s[12:15], s5 offen sc1
    buffer_load_dwordx4 v[60:63], v3, s[12:15], s6 offen sc1
    buffer_load_dwordx4 v[64:67], v46, s[12:15], s7 offen sc1
    s_waitcnt vmcnt(0)
    v_xor_b32 v48, s89, v48
    v_xor_b32 v49, s89, v49
    v_xor_b32 v50, s89, v50
    v_xor_b32 v51, s89, v51
    v_xor_b32 v52, s89, v52
    v_xor_b32 v53, s89, v53
    v_xor_b32 v54, s89, v54
    v_xor_b32 v55, s89, v55
    v_xor_b32 v56, s89, v56
    v_xor_b32 v57, s89, v57
    v_xor_b32 v58, s89, v58
    v_xor_b32 v59, s89, v59
    v_xor_b32 v60, s89, v60
    v_xor_b32 v61, s89, v61
    v_xor_b32 v62, s89, v62
    v_xor_b32 v63, s89, v63
    v_xor_b32 v64, s89, v64
    v_xor_b32 v65, s89, v65
    v_xor_b32 v66, s89, v66
    v_xor_b32 v67, s89, v67
    v_or_b32 v4, v48, v49
    v_or3_b32 v4, v4, v50, v51
    v_or3_b32 v4, v4, v52, v53
    v_or3_b32 v4, v4, v54, v55
    v_or3_b32 v4, v4, v56, v57
    v_or3_b32 v4, v4, v58, v59
    v_or3_b32 v4, v4, v60, v61
    v_or3_b32 v4, v4, v62, v63
    v_or3_b32 v4, v4, v64, v65
    v_or3_b32 v4, v4, v66, v67
    v_and_b32 v4, 7, v4
    v_cmp_ne_u16 vcc, 0, v4
    s_cbranch_vccz L_pd_51
    s_sub_u32 s69, s69, 1
    s_cbranch_scc0 L_pl_50
L_pd_51:
    v_pk_add_f32 v[32:33], v[48:49], v[52:53]
    v_pk_add_f32 v[34:35], v[50:51], v[54:55]
    v_pk_add_f32 v[36:37], v[56:57], v[60:61]
    v_pk_add_f32 v[38:39], v[58:59], v[62:63]
    s_mov_b32 exec_hi, 0
    v_pk_add_f32 v[32:33], v[32:33], v[64:65]
    v_pk_add_f32 v[34:35], v[34:35], v[66:67]
    s_mov_b32 exec_hi, -1
    v_pk_add_f32 v[32:33], v[32:33], v[36:37]
    v_pk_add_f32 v[34:35], v[34:35], v[38:39]
    s_nop 0
    v_add_f32_dpp v32, v32, v32 row_ror:8 row_mask:0xf bank_mask:0xf
    v_add_f32_dpp v33, v33, v33 row_ror:8 row_mask:0xf bank_mask:0xf
    v_add_f32_dpp v34, v34, v34 row_ror:8 row_mask:0xf bank_mask:0xf
    v_add_f32_dpp v35, v35, v35 row_ror:8 row_mask:0xf bank_mask:0xf
    v_add_f32_dpp v32, v32, v32 row_ror:4 row_mask:0xf bank_mask:0xf
    v_add_f32_dpp v33, v33, v33 row_ror:4 row_mask:0xf bank_mask:0xf
    v_add_f32_dpp v34, v34, v34 row_ror:4 row_mask:0xf bank_mask:0xf
    v_add_f32_dpp v35, v35, v35 row_ror:4 row_mask:0xf bank_mask:0xf
    v_add_f32_dpp v32, v32, v32 row_ror:2 row_mask:0xf bank_mask:0xf
    v_add_f32_dpp v33, v33, v33 row_ror:2 row_mask:0xf bank_mask:0xf
    v_add_f32_dpp v34, v34, v34 row_ror:2 row_mask:0xf bank_mask:0xf
    v_add_f32_dpp v35, v35, v35 row_ror:2 row_mask:0xf bank_mask:0xf
    v_mov_b32 v36, v32
    v_mov_b32 v37, v33
    v_mov_b32 v38, v34
    v_mov_b32 v39, v35
    v_permlane16_swap_b32 v32, v36
    v_permlane16_swap_b32 v33, v37
    v_permlane16_swap_b32 v34, v38
    v_permlane16_swap_b32 v35, v39
    v_add_f32 v32, v32, v36
    v_add_f32 v33, v33, v37
    v_add_f32 v34, v34, v38
    v_add_f32 v35, v35, v39
    v_mov_b32 v36, v32
    v_mov_b32 v37, v33
    v_mov_b32 v38, v34
    v_mov_b32 v39, v35
    v_permlane32_swap_b32 v32, v36
    v_permlane32_swap_b32 v33, v37
    v_permlane32_swap_b32 v34, v38
    v_permlane32_swap_b32 v35, v39
    v_add_f32 v32, v32, v36
    v_add_f32 v33, v33, v37
    v_add_f32 v34, v34, v38
    v_add_f32 v35, v35, v39
    v_cvt_pk_bf16_f32 v4, v32, v33
    v_lshlrev_b32 v32, 16, v4
    v_and_b32 v33, 0xffff0000, v4
    v_cvt_pk_bf16_f32 v4, v34, v35
    v_lshlrev_b32 v34, 16, v4
    v_and_b32 v35, 0xffff0000, v4
    v_mul_f32 v32, v32, v28
    v_mul_f32 v33, v33, v29
    v_mul_f32 v34, v34, v30
    v_mul_f32 v35, v35, v31
    v_cvt_pk_bf16_f32 v4, v32, v33
    v_lshlrev_b32 v32, 16, v4
    v_and_b32 v33, 0xffff0000, v4
    v_cvt_pk_bf16_f32 v4, v34, v35
    v_lshlrev_b32 v34, 16, v4
    v_and_b32 v35, 0xffff0000, v4
    v_add_f32 v20, v20, v32
    v_add_f32 v21, v21, v33
    v_add_f32 v22, v22, v34
    v_add_f32 v23, v23, v35
    v_cvt_pk_bf16_f32 v8, v20, v21
    v_cvt_pk_bf16_f32 v9, v22, v23
    buffer_store_dwordx2 v[8:9], v5, s[28:31], 0 offen
    s_lshl_b32 s3, s68, 4
    s_add_u32 s3, s3, s60
    s_cmp_eq_u32 s3, 1
    s_cbranch_scc0 L_Rend
    v_mov_b32 v8, s88
    v_mov_b32 v9, 114688
    v_cmp_eq_u32 vcc, 0, v1
    s_nop 1
    v_cndmask_b32 v9, v6, v9, vcc
    buffer_store_dword v8, v9, s[12:15], 0 offen sc1
L_Rend:
L_end:
    s_endpgm
.section .rodata,"a"
.p2align 6
.amdhsa_kernel adaLN_cond__mha_block_cached__geglu_ffn__decode_kernel
  .amdhsa_next_free_vgpr 128
  .amdhsa_next_free_sgpr 102
  .amdhsa_accum_offset 128
  .amdhsa_group_segment_fixed_size 0
  .amdhsa_kernarg_size 112
  .amdhsa_user_sgpr_count 2
  .amdhsa_user_sgpr_kernarg_segment_ptr 1
  .amdhsa_system_sgpr_workgroup_id_x 1
.end_amdhsa_kernel
```
